```python
import torch

def _softmax(x, axis=-1):
    return torch.softmax(x, dim=axis)
def _gelu(x):
    return torch.nn.functional.gelu(x, approximate="tanh")
def _silu(x):
    return torch.nn.functional.silu(x)
def _sigmoid(x):
    return torch.sigmoid(x)
def _layernorm(x, axis=-1, eps=1e-5):
    m = x.mean(dim=axis, keepdim=True)
    v = x.var(dim=axis, keepdim=True, unbiased=False)
    return (x - m) / torch.sqrt(v + eps)
def _scatter_add(tgt, idx, src, axis=0):
    return tgt.clone().index_add_(axis, idx, src)
def _segment_sum(src, seg, n):
    out = torch.zeros((n,) + src.shape[1:], dtype=src.dtype)
    return out.index_add_(0, seg, src)
def _pad(x, pw):
    flat = tuple(v for pair in reversed(pw) for v in pair)
    return torch.nn.functional.pad(x, flat)

kernel_name = 'parallel_sum__ssm_conv_s4d__mixer_channel_mlp__prompt'

def setup_inputs():

    _w = (lambda a: (lambda t: t.to(torch.bfloat16) if t.is_floating_point() else t)(torch.as_tensor(a)))
    def _A_setup():
        Bsz, L, D, N = 1, 2048, 512, 128
        return {
            "u": _w((lambda *s: torch.randn(*s, dtype=torch.bfloat16) * 0.05)(Bsz, L, D)),
            "log_A_real": _w((lambda *s: torch.randn(*s, dtype=torch.bfloat16) * 3.2)(D, N) * 0.5),
            "A_imag": _w((lambda *s: torch.randn(*s, dtype=torch.bfloat16) * 0.05)(D, N) * 3.14),
            "C_real": _w((lambda *s: torch.randn(*s, dtype=torch.bfloat16) * 0.1)(D, N) / N ** 0.5),
            "C_imag": _w((lambda *s: torch.randn(*s, dtype=torch.bfloat16) * 0.2)(D, N) / N ** 0.5),
            "log_dt": _w((lambda *s: torch.randn(*s, dtype=torch.bfloat16) * 0.05)(D) * 0.5 - 4.0),
            "D_skip": _w((lambda *s: torch.randn(*s, dtype=torch.bfloat16) * 0.05)(D)),
        }
    _A_in = _A_setup()

    def _B_setup():
        B, S, D, F = 1, 2048, 512, 1792
        return {
            "x": _w((lambda *s: torch.randn(*s, dtype=torch.bfloat16) * 0.05)(B, S, D)),
            "w1": _w((lambda *s: torch.randn(*s, dtype=torch.bfloat16) * 1.6)(D, F) * (D ** -0.5)),
            "b1": _w((lambda *s: torch.randn(*s, dtype=torch.bfloat16) * 0.8)(F)),
            "w2": _w((lambda *s: torch.randn(*s, dtype=torch.bfloat16) * 0.05)(F, D) * (F ** -0.5)),
            "b2": _w((lambda *s: torch.randn(*s, dtype=torch.bfloat16) * 0.05)(D)),
        }
    _B_in = _B_setup()

    return {
        "A_u": _A_in["u"],
        "A_log_A_real": _A_in["log_A_real"],
        "A_A_imag": _A_in["A_imag"],
        "A_C_real": _A_in["C_real"],
        "A_C_imag": _A_in["C_imag"],
        "A_log_dt": _A_in["log_dt"],
        "A_D_skip": _A_in["D_skip"],
        "B_x": _B_in["x"],
        "B_w1": _B_in["w1"],
        "B_b1": _B_in["b1"],
        "B_w2": _B_in["w2"],
        "B_b2": _B_in["b2"],
    }

def reference(A_u, A_log_A_real, A_A_imag, A_C_real, A_C_imag, A_log_dt, A_D_skip, B_x, B_w1, B_b1, B_w2, B_b2):
    def _A_ref(u, log_A_real, A_imag, C_real, C_imag, log_dt, D_skip):
        L = u.shape[1]
        dt = torch.exp(log_dt)
        A = -torch.exp(log_A_real) + 1j * A_imag
        C = (C_real + 1j * C_imag) * dt[:, None]
        pos = (lambda x, dt: x.to(dt))(torch.arange(L), log_dt.dtype)
        P = torch.exp((A * dt[:, None])[:, :, None] * pos[None, None, :])
        K = 2.0 * torch.einsum("dn,dnl->dl", C, P).real
        L2 = 2 * L
        u_t = (lambda x, *d: x.permute(*d))(u, 0, 2, 1)
        Kf = (lambda x, *a, **k: torch.fft.rfft(x.float(), *a, **k))(K, L2)
        Uf = (lambda x, *a, **k: torch.fft.rfft(x.float(), *a, **k))(u_t, L2)
        y = (lambda x, *a, **k: torch.fft.irfft(x, *a, **k).to(torch.bfloat16))(Uf * Kf[None, :, :], L2)[:, :, :L]
        y = (lambda x, *d: x.permute(*d))(y, 0, 2, 1)
        return y + u * D_skip[None, None, :]

    def _B_ref(x, w1, b1, w2, b2):
        y = _layernorm(x, axis=-1)
        h = _gelu(torch.einsum("bsd,df->bsf", y, w1) + b1)
        return torch.einsum("bsf,fd->bsd", h, w2) + b2

    x = A_u
    xn = _layernorm(x, axis=-1)
    return x + _A_ref(xn, A_log_A_real, A_A_imag, A_C_real, A_C_imag, A_log_dt, A_D_skip) + _B_ref(xn, B_w1, B_b1, B_w2, B_b2)
```

```asm
; @launch grid=(256,1,1) block=(512,1,1) lds=163840
.amdgcn_target "amdgcn-amd-amdhsa--gfx950"
.text
.globl parallel_sum__ssm_conv_s4d__mixer_channel_mlp__prompt_kernel
.p2align 8
.type parallel_sum__ssm_conv_s4d__mixer_channel_mlp__prompt_kernel,@function
parallel_sum__ssm_conv_s4d__mixer_channel_mlp__prompt_kernel:
    s_cmp_ge_u32 s2, 256
    s_cbranch_scc1 Lend
    s_load_dwordx16 s[4:19], s[0:1], 0
    s_load_dwordx8 s[20:27], s[0:1], 64
    s_load_dwordx4 s[28:31], s[0:1], 96
    s_load_dwordx2 s[32:33], s[0:1], 112
    s_getpc_b64 s[34:35]
Lpc:
    s_bfe_u32 s61, s2, 0x30003
    v_lshrrev_b32 v2, 4, v0
    v_lshl_add_u32 v2, s61, 5, v2
    v_lshlrev_b32 v2, 7, v2
    v_min_u32 v2, Lend-Lpc, v2
    v_mov_b32 v3, s35
    v_add_co_u32 v2, vcc, s34, v2
    s_nop 1
    v_addc_co_u32 v3, vcc, 0, v3, vcc
    global_load_dword a95, v[2:3], off
    v_lshrrev_b32 v10, 6, v0
    v_and_b32 v1, 63, v0
    v_readfirstlane_b32 s56, v10
    s_and_b32 s61, s2, 7
    s_lshr_b32 s62, s2, 3
    s_and_b32 s63, s62, 3
    s_lshr_b32 s69, s62, 2
    s_lshl2_add_u32 s3, s61, s63
    s_lshr_b32 s58, s61, 1
    s_lshl2_add_u32 s58, s58, s63
    s_and_b32 s61, s61, 1
    s_mul_i32 s62, s61, 7
    s_add_u32 s59, s62, s69
    s_add_u32 s61, s61, 14
    s_cmp_eq_u32 s69, 7
    s_cselect_b32 s59, s61, s59
    s_cmp_eq_u32 s69, 7
    s_cselect_b32 s100, 0, 0
    s_and_b32 s61, s69, 3
    s_xor_b32 s62, s69, 4
    s_cmp_eq_u32 s61, 3
    s_cselect_b32 s69, s62, s69
    s_and_b32 s57, s56, 3
    s_cmp_ge_u32 s56, 4
    s_cbranch_scc1 Lhelper
    s_cmp_ge_u32 s59, 14
    s_cbranch_scc1 Lln
    v_lshrrev_b32 v10, 3, v1
    v_lshrrev_b32 v11, 4, v1
    v_and_b32 v12, 7, v1
    v_xor_b32 v12, v12, v11
    v_lshlrev_b32 v12, 4, v12
    v_lshl_add_u32 v12, v10, 10, v12
    s_lshl_b32 s61, s57, 15
    v_add_u32 v2, s61, v12
    v_xor_b32 v13, 64, v2
    v_add_u32 v3, 7168, v13
    v_add_u32 v4, 14336, v2
    v_add_u32 v5, 21504, v13
    v_and_b32 v12, 15, v1
    v_lshlrev_b32 v13, 2, v11
    v_xor_b32 v12, v12, v13
    v_lshlrev_b32 v12, 4, v12
    s_lshl_b32 s61, s57, 4
    v_add_u32 v13, s61, v11
    v_mov_b32 v14, 3584
    v_mad_u32_u24 v6, v13, v14, v12
    v_add_u32 v7, 13312, v6
    v_add_u32 v8, 26624, v6
    v_add_u32 v9, 39936, v6
    s_lshl_b32 s66, s58, 17
    s_lshl_b32 s67, s59, 8
    s_lshl_b32 s68, s57, 12
    s_waitcnt lgkmcnt(0)
    s_mov_b32 s36, s4
    s_mov_b32 s37, s5
    s_mov_b32 s38, 0x200000
    s_mov_b32 s39, 0x00020000
    s_mov_b32 s40, s20
    s_mov_b32 s41, s21
    s_mov_b32 s42, 0x1c0000
    s_mov_b32 s43, 0x00020000
    s_add_u32 m0, s68, 0
    s_and_b32 s101, s69, 1
    s_lshl2_add_u32 s101, s101, 0
    s_and_b32 s101, s101, 7
    s_lshl_b32 s78, s101, 7
    s_add_u32 s78, s78, s66
    buffer_load_dwordx4 v2, s[36:39], s78 offen offset:0 lds
    buffer_load_dwordx4 v3, s[36:39], s78 offen offset:1024 lds
    buffer_load_dwordx4 v4, s[36:39], s78 offen offset:2048 lds
    buffer_load_dwordx4 v5, s[36:39], s78 offen offset:3072 lds
    s_add_u32 m0, s68, 16384
    s_mul_i32 s78, s101, 229376
    s_add_u32 s78, s78, s67
    buffer_load_dwordx4 v6, s[40:43], s78 offen offset:0 lds
    buffer_load_dwordx4 v7, s[40:43], s78 offen offset:1024 lds
    buffer_load_dwordx4 v8, s[40:43], s78 offen offset:2048 lds
    buffer_load_dwordx4 v9, s[40:43], s78 offen offset:3072 lds
    v_and_b32 v157, 3, v1
    v_lshlrev_b32 v157, 2, v157
    v_add_u32 v157, 157440, v157
    s_lshl2_add_u32 s61, s57, 157440
    v_mov_b32 v158, s61
    v_mov_b32 v159, 0
    ds_write2_b32 v158, v159, v159 offset0:16 offset1:20
    ds_write_b32 v158, v159 offset:96
    s_waitcnt lgkmcnt(0)
    s_mov_b32 s48, s32
    s_mov_b32 s49, s33
    s_mov_b32 s50, 0x10000000
    s_mov_b32 s51, 0x00020000
    s_load_dword s60, s[32:33], 0x10000
    s_barrier
    v_lshrrev_b32 v10, 5, v1
    s_and_b32 s61, s57, 1
    s_lshr_b32 s62, s57, 1
    s_lshl_b32 s63, s61, 1
    s_add_u32 s63, s63, s62
    s_lshl_b32 s64, s63, 6
    s_add_u32 s64, s64, s67
    v_lshlrev_b32 v11, 3, v10
    v_add_u32 v11, s64, v11
    v_xor_b32 v12, 64, v11
    s_add_u32 m0, s68, 32768
    s_and_b32 s101, s69, 1
    s_lshl2_add_u32 s101, s101, 1
    s_and_b32 s101, s101, 7
    s_lshl_b32 s78, s101, 7
    s_add_u32 s78, s78, s66
    buffer_load_dwordx4 v2, s[36:39], s78 offen offset:0 lds
    buffer_load_dwordx4 v3, s[36:39], s78 offen offset:1024 lds
    buffer_load_dwordx4 v4, s[36:39], s78 offen offset:2048 lds
    buffer_load_dwordx4 v5, s[36:39], s78 offen offset:3072 lds
    s_add_u32 m0, s68, 49152
    s_mul_i32 s78, s101, 229376
    s_add_u32 s78, s78, s67
    buffer_load_dwordx4 v6, s[40:43], s78 offen offset:0 lds
    buffer_load_dwordx4 v7, s[40:43], s78 offen offset:1024 lds
    buffer_load_dwordx4 v8, s[40:43], s78 offen offset:2048 lds
    buffer_load_dwordx4 v9, s[40:43], s78 offen offset:3072 lds
    global_load_dwordx2 v[96:97], v11, s[22:23] offset:0
    global_load_dwordx2 v[98:99], v11, s[22:23] offset:16
    global_load_dwordx2 v[100:101], v11, s[22:23] offset:32
    global_load_dwordx2 v[102:103], v11, s[22:23] offset:48
    global_load_dwordx2 v[104:105], v12, s[22:23] offset:0
    global_load_dwordx2 v[106:107], v12, s[22:23] offset:16
    global_load_dwordx2 v[108:109], v12, s[22:23] offset:32
    global_load_dwordx2 v[110:111], v12, s[22:23] offset:48
    s_lshl_b32 s10, s69, 7
    v_lshl_add_u32 v13, v1, 2, s10
    s_mov_b32 m0, 159616
    s_mov_b32 exec_hi, 0
    global_load_lds_dword v13, s[26:27]
    s_mov_b32 exec_hi, -1
    v_and_b32 v13, 31, v1
    v_bfe_u32 v14, v1, 1, 3
    s_add_u32 m0, s68, 65536
    s_and_b32 s101, s69, 1
    s_lshl2_add_u32 s101, s101, 2
    s_and_b32 s101, s101, 7
    s_lshl_b32 s78, s101, 7
    s_add_u32 s78, s78, s66
    buffer_load_dwordx4 v2, s[36:39], s78 offen offset:0 lds
    v_xor_b32 v14, v14, v10
    v_lshlrev_b32 v14, 4, v14
    v_lshl_add_u32 v14, v13, 7, v14
    s_lshl_b32 s64, s62, 13
    s_lshl_b32 s61, s63, 7
    buffer_load_dwordx4 v3, s[36:39], s78 offen offset:1024 lds
    s_add_u32 s61, s61, 156928
    v_lshlrev_b32 v15, 4, v10
    v_add_u32 v26, s61, v15
    v_xor_b32 v28, 128, v26
    buffer_load_dwordx4 v4, s[36:39], s78 offen offset:2048 lds
    v_bfe_u32 v15, v1, 2, 2
    v_lshl_add_u32 v16, v10, 3, v15
    v_lshlrev_b32 v16, 8, v16
    v_xor_b32 v15, s63, v15
    v_lshl_add_u32 v16, v15, 6, v16
    buffer_load_dwordx4 v5, s[36:39], s78 offen offset:3072 lds
    v_bfe_u32 v15, v1, 4, 1
    v_lshl_add_u32 v16, v15, 5, v16
    v_and_b32 v15, 3, v1
    v_lshl_add_u32 v16, v15, 3, v16
    s_add_u32 m0, s68, 81920
    s_mul_i32 s78, s101, 229376
    s_add_u32 s78, s78, s67
    buffer_load_dwordx4 v6, s[40:43], s78 offen offset:0 lds
    v_add_u32 v18, 16384, v16
    v_xor_b32 v19, 64, v18
    v_add_u32 v20, 0x10000, v18
    v_add_u32 v21, 0x10000, v19
    v_add_u32 v10, s64, v14
    buffer_load_dwordx4 v7, s[40:43], s78 offen offset:1024 lds
    v_xor_b32 v11, 32, v10
    v_xor_b32 v12, 64, v10
    v_xor_b32 v13, 96, v10
    v_add_u32 v14, 0x10000, v10
    buffer_load_dwordx4 v8, s[40:43], s78 offen offset:2048 lds
    v_add_u32 v15, 0x10000, v11
    v_add_u32 v16, 0x10000, v12
    v_add_u32 v17, 0x10000, v13
    v_mov_b32 v22, 0x3f803f80
    v_mov_b32 v23, 0x3f803f80
    buffer_load_dwordx4 v9, s[40:43], s78 offen offset:3072 lds
    v_mov_b32 v24, 0x3f803f80
    v_mov_b32 v25, 0x3f803f80
    s_waitcnt lgkmcnt(0)
    s_add_u32 s60, s60, 1
    v_mov_b32 v159, 1
    s_waitcnt vmcnt(25)
    ds_write_b32 v158, v159 offset:96
    ds_read_b32 v27, v157 offset:96
    s_waitcnt lgkmcnt(0)
    v_cmp_gt_u32 vcc, 1, v27
    s_nop 0
    s_cbranch_vccnz Lvp1
Lvk2:
    ds_read_b64_tr_b16 a[0:1], v18 offset:0
    ds_read_b64_tr_b16 a[2:3], v18 offset:1024
    ds_read_b128 a[8:11], v10 offset:0
    ds_read_b128 a[12:15], v10 offset:4096
    ds_read_b64_tr_b16 a[4:5], v19 offset:0
    ds_read_b64_tr_b16 a[6:7], v19 offset:1024
    s_waitcnt lgkmcnt(4)
    v_mfma_f32_32x32x16_bf16 a[32:47], a[0:3], v[22:25], 0
    ds_read_b64_tr_b16 a[16:17], v18 offset:4096
    ds_read_b64_tr_b16 a[18:19], v18 offset:5120
    s_waitcnt lgkmcnt(5)
    v_mfma_f32_32x32x16_bf16 v[32:47], a[0:3], a[8:11], 0
    ds_read_b128 a[24:27], v11 offset:0
    ds_read_b128 a[28:31], v11 offset:4096
    s_waitcnt lgkmcnt(6)
    v_mfma_f32_32x32x16_bf16 v[48:63], a[0:3], a[12:15], 0
    s_add_u32 m0, s68, 98304
    s_and_b32 s101, s69, 1
    s_lshl2_add_u32 s101, s101, 3
    s_and_b32 s101, s101, 7
    s_lshl_b32 s78, s101, 7
    s_add_u32 s78, s78, s66
    buffer_load_dwordx4 v2, s[36:39], s78 offen offset:0 lds
    ds_read_b64_tr_b16 a[20:21], v19 offset:4096
    ds_read_b64_tr_b16 a[22:23], v19 offset:5120
    s_waitcnt lgkmcnt(6)
    v_mfma_f32_32x32x16_bf16 v[64:79], a[4:7], a[8:11], 0
    v_mfma_f32_32x32x16_bf16 v[80:95], a[4:7], a[12:15], 0
    buffer_load_dwordx4 v3, s[36:39], s78 offen offset:1024 lds
    s_waitcnt lgkmcnt(4)
    v_mfma_f32_32x32x16_bf16 a[32:47], a[16:19], v[22:25], a[32:47]
    ds_read_b64_tr_b16 a[0:1], v18 offset:8192
    ds_read_b64_tr_b16 a[2:3], v18 offset:9216
    s_waitcnt lgkmcnt(5)
    v_mfma_f32_32x32x16_bf16 v[32:47], a[16:19], a[24:27], v[32:47]
    ds_read_b128 a[8:11], v12 offset:0
    ds_read_b128 a[12:15], v12 offset:4096
    buffer_load_dwordx4 v4, s[36:39], s78 offen offset:2048 lds
    s_waitcnt lgkmcnt(6)
    v_mfma_f32_32x32x16_bf16 v[48:63], a[16:19], a[28:31], v[48:63]
    ds_read_b64_tr_b16 a[4:5], v19 offset:8192
    ds_read_b64_tr_b16 a[6:7], v19 offset:9216
    s_waitcnt lgkmcnt(6)
    v_mfma_f32_32x32x16_bf16 v[64:79], a[20:23], a[24:27], v[64:79]
    v_mfma_f32_32x32x16_bf16 v[80:95], a[20:23], a[28:31], v[80:95]
    buffer_load_dwordx4 v5, s[36:39], s78 offen offset:3072 lds
    s_waitcnt lgkmcnt(4)
    v_mfma_f32_32x32x16_bf16 a[32:47], a[0:3], v[22:25], a[32:47]
    v_mov_b32 v159, 1
    ds_read_b64_tr_b16 a[16:17], v18 offset:12288
    ds_read_b64_tr_b16 a[18:19], v18 offset:13312
    s_waitcnt lgkmcnt(5)
    v_mfma_f32_32x32x16_bf16 v[32:47], a[0:3], a[8:11], v[32:47]
    s_waitcnt vmcnt(21)
    ds_write_b32 v158, v159 offset:64
    ds_read_b128 a[24:27], v13 offset:0
    ds_read_b128 a[28:31], v13 offset:4096
    s_waitcnt lgkmcnt(7)
    v_mfma_f32_32x32x16_bf16 v[48:63], a[0:3], a[12:15], v[48:63]
    ds_read_b64_tr_b16 a[20:21], v19 offset:12288
    ds_read_b64_tr_b16 a[22:23], v19 offset:13312
    v_lshlrev_b32 v29, 4, v1
    v_mov_b32 v30, 0xbdd2d3e8
    v_mov_b32 v31, 0xbdd2d3e8
    s_mov_b32 s4, 0xc0135761
    s_mov_b32 s5, 0xc0135761
    s_waitcnt lgkmcnt(7)
    v_mfma_f32_32x32x16_bf16 v[64:79], a[4:7], a[8:11], v[64:79]
    s_add_u32 m0, s68, 114688
    s_mul_i32 s78, s101, 229376
    s_add_u32 s78, s78, s67
    buffer_load_dwordx4 v6, s[40:43], s78 offen offset:0 lds
    s_mov_b32 s6, 1.0
    s_mov_b32 s7, 1.0
    s_lshl_b32 s61, s58, 2
    s_lshl_b32 s64, s62, 1
    s_add_u32 s61, s61, s64
    v_mfma_f32_32x32x16_bf16 v[80:95], a[4:7], a[12:15], v[80:95]
    buffer_load_dwordx4 v7, s[40:43], s78 offen offset:1024 lds
    ds_read_b32 v27, v157 offset:64
    s_waitcnt lgkmcnt(6)
    v_mfma_f32_32x32x16_bf16 a[32:47], a[16:19], v[22:25], a[32:47]
    s_waitcnt lgkmcnt(0)
    ds_write_b32 v158, v159 offset:80
    v_cmp_gt_u32 vcc, 1, v27
    s_nop 0
    s_cbranch_vccnz Lvp4
Lvk5:
    ds_read_b64_tr_b16 a[0:1], v18 offset:32768
    ds_read_b64_tr_b16 a[2:3], v18 offset:33792
    ds_read_b128 a[8:11], v10 offset:32768
    v_mfma_f32_32x32x16_bf16 v[32:47], a[16:19], a[24:27], v[32:47]
    ds_read_b128 a[12:15], v10 offset:36864
    ds_read_b64_tr_b16 a[4:5], v19 offset:32768
    ds_read_b64_tr_b16 a[6:7], v19 offset:33792
    v_mfma_f32_32x32x16_bf16 v[48:63], a[16:19], a[28:31], v[48:63]
    buffer_load_dwordx4 v8, s[40:43], s78 offen offset:2048 lds
    v_mfma_f32_32x32x16_bf16 v[64:79], a[20:23], a[24:27], v[64:79]
    s_mul_i32 s61, s61, 112
    s_lshl_b32 s64, s59, 3
    s_add_u32 s61, s61, s64
    s_lshl_b32 s61, s61, 10
    s_add_u32 s61, s61, 0x500000
    v_mfma_f32_32x32x16_bf16 v[80:95], a[20:23], a[28:31], v[80:95]
    buffer_load_dwordx4 v9, s[40:43], s78 offen offset:3072 lds
    s_waitcnt lgkmcnt(4)
    v_mfma_f32_32x32x16_bf16 a[32:47], a[0:3], v[22:25], a[32:47]
    ds_read_b32 v27, v157 offset:80
    ds_read_b64_tr_b16 a[16:17], v18 offset:36864
    ds_read_b64_tr_b16 a[18:19], v18 offset:37888
    s_waitcnt lgkmcnt(6)
    v_mfma_f32_32x32x16_bf16 v[32:47], a[0:3], a[8:11], v[32:47]
    ds_read_b128 a[24:27], v11 offset:32768
    ds_read_b128 a[28:31], v11 offset:36864
    s_waitcnt lgkmcnt(7)
    v_mfma_f32_32x32x16_bf16 v[48:63], a[0:3], a[12:15], v[48:63]
    s_waitcnt lgkmcnt(4)
    v_cmp_gt_u32 vcc, 1, v27
    s_nop 0
    s_cbranch_vccnz Lvp7
Lvk8:
    s_add_u32 m0, s68, 0
    s_and_b32 s101, s69, 1
    s_lshl2_add_u32 s101, s101, 4
    s_and_b32 s101, s101, 7
    s_lshl_b32 s78, s101, 7
    s_add_u32 s78, s78, s66
    buffer_load_dwordx4 v2, s[36:39], s78 offen offset:0 lds
    ds_read_b64_tr_b16 a[20:21], v19 offset:36864
    ds_read_b64_tr_b16 a[22:23], v19 offset:37888
    s_lshl_b32 s64, s63, 11
    s_add_u32 s70, s61, s64
    s_add_u32 s71, s70, 114688
    s_xor_b32 s64, s64, 2048
    s_add_u32 s72, s61, s64
    v_mfma_f32_32x32x16_bf16 v[64:79], a[4:7], a[8:11], v[64:79]
    s_add_u32 s73, s72, 114688
    v_lshrrev_b32 v154, 5, v1
    v_bfe_u32 v155, v1, 2, 2
    v_lshl_add_u32 v154, v154, 2, v155
    v_lshlrev_b32 v154, 7, v154
    v_mfma_f32_32x32x16_bf16 v[80:95], a[4:7], a[12:15], v[80:95]
    buffer_load_dwordx4 v3, s[36:39], s78 offen offset:1024 lds
    s_waitcnt lgkmcnt(4)
    v_mfma_f32_32x32x16_bf16 a[32:47], a[16:19], v[22:25], a[32:47]
    ds_read_b64_tr_b16 a[0:1], v18 offset:40960
    ds_read_b64_tr_b16 a[2:3], v18 offset:41984
    s_waitcnt lgkmcnt(5)
    v_mfma_f32_32x32x16_bf16 v[32:47], a[16:19], a[24:27], v[32:47]
    ds_read_b128 a[8:11], v12 offset:32768
    ds_read_b128 a[12:15], v12 offset:36864
    buffer_load_dwordx4 v4, s[36:39], s78 offen offset:2048 lds
    s_waitcnt lgkmcnt(6)
    v_mfma_f32_32x32x16_bf16 v[48:63], a[16:19], a[28:31], v[48:63]
    ds_read_b64_tr_b16 a[4:5], v19 offset:40960
    ds_read_b64_tr_b16 a[6:7], v19 offset:41984
    v_bfe_u32 v155, v1, 3, 1
    s_and_b32 s61, s57, 1
    v_xor_b32 v155, s61, v155
    v_lshl_add_u32 v154, v155, 6, v154
    v_bfe_u32 v155, v1, 4, 1
    s_waitcnt lgkmcnt(6)
    v_mfma_f32_32x32x16_bf16 v[64:79], a[20:23], a[24:27], v[64:79]
    v_lshl_add_u32 v154, v155, 5, v154
    v_and_b32 v155, 3, v1
    v_lshl_add_u32 v154, v155, 3, v154
    s_lshl_b32 s61, s57, 13
    v_add_u32 v144, s61, v154
    v_mfma_f32_32x32x16_bf16 v[80:95], a[20:23], a[28:31], v[80:95]
    buffer_load_dwordx4 v5, s[36:39], s78 offen offset:3072 lds
    s_waitcnt lgkmcnt(4)
    v_mfma_f32_32x32x16_bf16 a[32:47], a[0:3], v[22:25], a[32:47]
    v_mov_b32 v159, 2
    ds_read_b64_tr_b16 a[16:17], v18 offset:45056
    ds_read_b64_tr_b16 a[18:19], v18 offset:46080
    s_waitcnt lgkmcnt(5)
    v_mfma_f32_32x32x16_bf16 v[32:47], a[0:3], a[8:11], v[32:47]
    s_waitcnt vmcnt(12)
    ds_write_b32 v158, v159 offset:64
    ds_read_b128 a[24:27], v13 offset:32768
    ds_read_b128 a[28:31], v13 offset:36864
    s_waitcnt lgkmcnt(7)
    v_mfma_f32_32x32x16_bf16 v[48:63], a[0:3], a[12:15], v[48:63]
    ds_read_b64_tr_b16 a[20:21], v19 offset:45056
    ds_read_b64_tr_b16 a[22:23], v19 offset:46080
    v_xor_b32 v145, 64, v144
    v_add_u32 v146, 0x10000, v144
    v_add_u32 v147, 0x10000, v145
    s_mov_b32 s44, s24
    s_mov_b32 s45, s25
    s_waitcnt lgkmcnt(7)
    v_mfma_f32_32x32x16_bf16 v[64:79], a[4:7], a[8:11], v[64:79]
    s_add_u32 m0, s68, 16384
    s_mul_i32 s78, s101, 229376
    s_add_u32 s78, s78, s67
    buffer_load_dwordx4 v6, s[40:43], s78 offen offset:0 lds
    s_mov_b32 s46, 0x1c0000
    s_mov_b32 s47, 0x00020000
    v_lshrrev_b32 v154, 3, v1
    v_and_b32 v155, 7, v1
    v_bfe_u32 v156, v1, 4, 1
    v_mfma_f32_32x32x16_bf16 v[80:95], a[4:7], a[12:15], v[80:95]
    buffer_load_dwordx4 v7, s[40:43], s78 offen offset:1024 lds
    ds_read_b32 v27, v157 offset:64
    s_waitcnt lgkmcnt(6)
    v_mfma_f32_32x32x16_bf16 a[32:47], a[16:19], v[22:25], a[32:47]
    s_waitcnt lgkmcnt(0)
    ds_write_b32 v158, v159 offset:80
    v_cmp_gt_u32 vcc, 2, v27
    s_nop 0
    s_cbranch_vccnz Lvp10
Lvk11:
    ds_read_b64_tr_b16 a[0:1], v20 offset:0
    ds_read_b64_tr_b16 a[2:3], v20 offset:1024
    ds_read_b128 a[8:11], v14 offset:0
    v_mfma_f32_32x32x16_bf16 v[32:47], a[16:19], a[24:27], v[32:47]
    ds_read_b128 a[12:15], v14 offset:4096
    ds_read_b64_tr_b16 a[4:5], v21 offset:0
    ds_read_b64_tr_b16 a[6:7], v21 offset:1024
    v_mfma_f32_32x32x16_bf16 v[48:63], a[16:19], a[28:31], v[48:63]
    buffer_load_dwordx4 v8, s[40:43], s78 offen offset:2048 lds
    v_mfma_f32_32x32x16_bf16 v[64:79], a[20:23], a[24:27], v[64:79]
    v_lshlrev_b32 v156, 2, v156
    v_xor_b32 v155, v155, v156
    v_lshlrev_b32 v155, 4, v155
    v_lshl_add_u32 v0, v154, 10, v155
    v_add_u32 v148, 7168, v0
    v_mfma_f32_32x32x16_bf16 v[80:95], a[20:23], a[28:31], v[80:95]
    buffer_load_dwordx4 v9, s[40:43], s78 offen offset:3072 lds
    s_waitcnt lgkmcnt(4)
    v_mfma_f32_32x32x16_bf16 a[32:47], a[0:3], v[22:25], a[32:47]
    ds_read_b32 v27, v157 offset:80
    ds_read_b64_tr_b16 a[16:17], v20 offset:4096
    ds_read_b64_tr_b16 a[18:19], v20 offset:5120
    s_waitcnt lgkmcnt(6)
    v_mfma_f32_32x32x16_bf16 v[32:47], a[0:3], a[8:11], v[32:47]
    ds_read_b128 a[24:27], v15 offset:0
    ds_read_b128 a[28:31], v15 offset:4096
    s_waitcnt lgkmcnt(7)
    v_mfma_f32_32x32x16_bf16 v[48:63], a[0:3], a[12:15], v[48:63]
    s_waitcnt lgkmcnt(4)
    v_cmp_gt_u32 vcc, 2, v27
    s_nop 0
    s_cbranch_vccnz Lvp13
Lvk14:
    s_add_u32 m0, s68, 32768
    s_and_b32 s101, s69, 1
    s_lshl2_add_u32 s101, s101, 5
    s_and_b32 s101, s101, 7
    s_lshl_b32 s78, s101, 7
    s_add_u32 s78, s78, s66
    buffer_load_dwordx4 v2, s[36:39], s78 offen offset:0 lds
    ds_read_b64_tr_b16 a[20:21], v21 offset:4096
    ds_read_b64_tr_b16 a[22:23], v21 offset:5120
    v_add_u32 v149, 14336, v0
    v_add_u32 v150, 21504, v0
    s_mul_i32 s34, s57, 458752
    s_lshl_b32 s77, s69, 7
    s_add_u32 s34, s34, s77
    v_mfma_f32_32x32x16_bf16 v[64:79], a[4:7], a[8:11], v[64:79]
    s_add_u32 s35, s34, 458752
    s_lshl_b32 s76, s100, 16
    s_add_u32 s76, s76, s34
    s_lshl_b32 s77, s57, 13
    s_lshr_b32 s61, s57, 1
    v_mfma_f32_32x32x16_bf16 v[80:95], a[4:7], a[12:15], v[80:95]
    buffer_load_dwordx4 v3, s[36:39], s78 offen offset:1024 lds
    s_waitcnt lgkmcnt(4)
    v_mfma_f32_32x32x16_bf16 a[32:47], a[16:19], v[22:25], a[32:47]
    ds_read_b64_tr_b16 a[0:1], v20 offset:8192
    ds_read_b64_tr_b16 a[2:3], v20 offset:9216
    s_waitcnt lgkmcnt(5)
    v_mfma_f32_32x32x16_bf16 v[32:47], a[16:19], a[24:27], v[32:47]
    ds_read_b128 a[8:11], v16 offset:0
    ds_read_b128 a[12:15], v16 offset:4096
    buffer_load_dwordx4 v4, s[36:39], s78 offen offset:2048 lds
    s_waitcnt lgkmcnt(6)
    v_mfma_f32_32x32x16_bf16 v[48:63], a[16:19], a[28:31], v[48:63]
    ds_read_b64_tr_b16 a[4:5], v21 offset:8192
    ds_read_b64_tr_b16 a[6:7], v21 offset:9216
    s_mul_i32 s62, s61, 114688
    s_sub_u32 s63, 114688, s62
    v_lshlrev_b32 v156, 4, v1
    v_add_u32 v152, s62, v156
    v_add_u32 v151, s63, v156
    s_waitcnt lgkmcnt(6)
    v_mfma_f32_32x32x16_bf16 v[64:79], a[20:23], a[24:27], v[64:79]
    s_lshl_b32 s61, s58, 11
    s_lshr_b32 s62, s57, 1
    s_lshl_b32 s62, s62, 10
    s_add_u32 s61, s61, s62
    v_and_b32 v153, 31, v1
    v_mfma_f32_32x32x16_bf16 v[80:95], a[20:23], a[28:31], v[80:95]
    buffer_load_dwordx4 v5, s[36:39], s78 offen offset:3072 lds
    s_waitcnt lgkmcnt(4)
    v_mfma_f32_32x32x16_bf16 a[32:47], a[0:3], v[22:25], a[32:47]
    v_mov_b32 v159, 3
    ds_read_b64_tr_b16 a[16:17], v20 offset:12288
    ds_read_b64_tr_b16 a[18:19], v20 offset:13312
    s_waitcnt lgkmcnt(5)
    v_mfma_f32_32x32x16_bf16 v[32:47], a[0:3], a[8:11], v[32:47]
    s_waitcnt vmcnt(12)
    ds_write_b32 v158, v159 offset:64
    ds_read_b128 a[24:27], v17 offset:0
    ds_read_b128 a[28:31], v17 offset:4096
    s_waitcnt lgkmcnt(7)
    v_mfma_f32_32x32x16_bf16 v[48:63], a[0:3], a[12:15], v[48:63]
    ds_read_b64_tr_b16 a[20:21], v21 offset:12288
    ds_read_b64_tr_b16 a[22:23], v21 offset:13312
    v_lshlrev_b32 v153, 4, v153
    v_add_u32 v153, s61, v153
    s_lshl_b32 s61, s58, 1
    s_lshr_b32 s62, s57, 1
    s_add_u32 s61, s61, s62
    s_waitcnt lgkmcnt(7)
    v_mfma_f32_32x32x16_bf16 v[64:79], a[4:7], a[8:11], v[64:79]
    s_add_u32 m0, s68, 49152
    s_mul_i32 s78, s101, 229376
    s_add_u32 s78, s78, s67
    buffer_load_dwordx4 v6, s[40:43], s78 offen offset:0 lds
    s_mul_i32 s61, s61, 28
    s_lshl_b32 s62, s59, 1
    s_add_u32 s61, s61, s62
    s_and_b32 s62, s57, 1
    s_add_u32 s61, s61, s62
    v_mfma_f32_32x32x16_bf16 v[80:95], a[4:7], a[12:15], v[80:95]
    buffer_load_dwordx4 v7, s[40:43], s78 offen offset:1024 lds
    ds_read_b32 v27, v157 offset:64
    s_waitcnt lgkmcnt(6)
    v_mfma_f32_32x32x16_bf16 a[32:47], a[16:19], v[22:25], a[32:47]
    s_waitcnt lgkmcnt(0)
    ds_write_b32 v158, v159 offset:80
    v_cmp_gt_u32 vcc, 3, v27
    s_nop 0
    s_cbranch_vccnz Lvp16
Lvk17:
    ds_read_b64_tr_b16 a[0:1], v20 offset:32768
    ds_read_b64_tr_b16 a[2:3], v20 offset:33792
    ds_read_b128 a[8:11], v14 offset:32768
    v_mfma_f32_32x32x16_bf16 v[32:47], a[16:19], a[24:27], v[32:47]
    ds_read_b128 a[12:15], v14 offset:36864
    ds_read_b64_tr_b16 a[4:5], v21 offset:32768
    ds_read_b64_tr_b16 a[6:7], v21 offset:33792
    v_mfma_f32_32x32x16_bf16 v[48:63], a[16:19], a[28:31], v[48:63]
    buffer_load_dwordx4 v8, s[40:43], s78 offen offset:2048 lds
    v_mfma_f32_32x32x16_bf16 v[64:79], a[20:23], a[24:27], v[64:79]
    s_lshl_b32 s61, s61, 7
    s_add_u32 s79, s61, 0x20000
    v_lshlrev_b32 v112, 16, v96
    v_and_b32 v113, 0xffff0000, v96
    v_lshlrev_b32 v114, 16, v97
    v_mfma_f32_32x32x16_bf16 v[80:95], a[20:23], a[28:31], v[80:95]
    buffer_load_dwordx4 v9, s[40:43], s78 offen offset:3072 lds
    s_waitcnt lgkmcnt(4)
    v_mfma_f32_32x32x16_bf16 a[32:47], a[0:3], v[22:25], a[32:47]
    ds_read_b32 v27, v157 offset:80
    ds_read_b64_tr_b16 a[16:17], v20 offset:36864
    ds_read_b64_tr_b16 a[18:19], v20 offset:37888
    s_waitcnt lgkmcnt(6)
    v_mfma_f32_32x32x16_bf16 v[32:47], a[0:3], a[8:11], v[32:47]
    ds_read_b128 a[24:27], v15 offset:32768
    ds_read_b128 a[28:31], v15 offset:36864
    s_waitcnt lgkmcnt(7)
    v_mfma_f32_32x32x16_bf16 v[48:63], a[0:3], a[12:15], v[48:63]
    s_waitcnt lgkmcnt(4)
    v_cmp_gt_u32 vcc, 3, v27
    s_nop 0
    s_cbranch_vccnz Lvp19
Lvk20:
    s_add_u32 m0, s68, 65536
    s_and_b32 s101, s69, 1
    s_lshl2_add_u32 s101, s101, 6
    s_and_b32 s101, s101, 7
    s_lshl_b32 s78, s101, 7
    s_add_u32 s78, s78, s66
    buffer_load_dwordx4 v2, s[36:39], s78 offen offset:0 lds
    ds_read_b64_tr_b16 a[20:21], v21 offset:36864
    ds_read_b64_tr_b16 a[22:23], v21 offset:37888
    v_and_b32 v115, 0xffff0000, v97
    v_lshlrev_b32 v116, 16, v98
    v_and_b32 v117, 0xffff0000, v98
    v_lshlrev_b32 v118, 16, v99
    v_and_b32 v119, 0xffff0000, v99
    v_mfma_f32_32x32x16_bf16 v[64:79], a[4:7], a[8:11], v[64:79]
    v_lshlrev_b32 v120, 16, v100
    v_and_b32 v121, 0xffff0000, v100
    v_lshlrev_b32 v122, 16, v101
    v_and_b32 v123, 0xffff0000, v101
    v_lshlrev_b32 v124, 16, v102
    v_mfma_f32_32x32x16_bf16 v[80:95], a[4:7], a[12:15], v[80:95]
    buffer_load_dwordx4 v3, s[36:39], s78 offen offset:1024 lds
    s_waitcnt lgkmcnt(4)
    v_mfma_f32_32x32x16_bf16 a[32:47], a[16:19], v[22:25], a[32:47]
    ds_read_b64_tr_b16 a[0:1], v20 offset:40960
    ds_read_b64_tr_b16 a[2:3], v20 offset:41984
    s_waitcnt lgkmcnt(5)
    v_mfma_f32_32x32x16_bf16 v[32:47], a[16:19], a[24:27], v[32:47]
    ds_read_b128 a[8:11], v16 offset:32768
    ds_read_b128 a[12:15], v16 offset:36864
    buffer_load_dwordx4 v4, s[36:39], s78 offen offset:2048 lds
    s_waitcnt lgkmcnt(6)
    v_mfma_f32_32x32x16_bf16 v[48:63], a[16:19], a[28:31], v[48:63]
    ds_read_b64_tr_b16 a[4:5], v21 offset:40960
    ds_read_b64_tr_b16 a[6:7], v21 offset:41984
    v_and_b32 v125, 0xffff0000, v102
    v_lshlrev_b32 v126, 16, v103
    v_and_b32 v127, 0xffff0000, v103
    v_lshlrev_b32 v128, 16, v104
    v_and_b32 v129, 0xffff0000, v104
    s_waitcnt lgkmcnt(6)
    v_mfma_f32_32x32x16_bf16 v[64:79], a[20:23], a[24:27], v[64:79]
    v_lshlrev_b32 v130, 16, v105
    v_and_b32 v131, 0xffff0000, v105
    v_lshlrev_b32 v132, 16, v106
    v_and_b32 v133, 0xffff0000, v106
    v_lshlrev_b32 v134, 16, v107
    v_mfma_f32_32x32x16_bf16 v[80:95], a[20:23], a[28:31], v[80:95]
    buffer_load_dwordx4 v5, s[36:39], s78 offen offset:3072 lds
    s_waitcnt lgkmcnt(4)
    v_mfma_f32_32x32x16_bf16 a[32:47], a[0:3], v[22:25], a[32:47]
    v_mov_b32 v159, 4
    ds_read_b64_tr_b16 a[16:17], v20 offset:45056
    ds_read_b64_tr_b16 a[18:19], v20 offset:46080
    s_waitcnt lgkmcnt(5)
    v_mfma_f32_32x32x16_bf16 v[32:47], a[0:3], a[8:11], v[32:47]
    s_waitcnt vmcnt(12)
    ds_write_b32 v158, v159 offset:64
    ds_read_b128 a[24:27], v17 offset:32768
    ds_read_b128 a[28:31], v17 offset:36864
    s_waitcnt lgkmcnt(7)
    v_mfma_f32_32x32x16_bf16 v[48:63], a[0:3], a[12:15], v[48:63]
    ds_read_b64_tr_b16 a[20:21], v21 offset:45056
    ds_read_b64_tr_b16 a[22:23], v21 offset:46080
    v_and_b32 v135, 0xffff0000, v107
    v_lshlrev_b32 v136, 16, v108
    v_and_b32 v137, 0xffff0000, v108
    v_lshlrev_b32 v138, 16, v109
    v_and_b32 v139, 0xffff0000, v109
    s_waitcnt lgkmcnt(7)
    v_mfma_f32_32x32x16_bf16 v[64:79], a[4:7], a[8:11], v[64:79]
    s_add_u32 m0, s68, 81920
    s_mul_i32 s78, s101, 229376
    s_add_u32 s78, s78, s67
    buffer_load_dwordx4 v6, s[40:43], s78 offen offset:0 lds
    v_lshlrev_b32 v140, 16, v110
    v_and_b32 v141, 0xffff0000, v110
    v_lshlrev_b32 v142, 16, v111
    v_and_b32 v143, 0xffff0000, v111
    v_mfma_f32_32x32x16_bf16 v[80:95], a[4:7], a[12:15], v[80:95]
    buffer_load_dwordx4 v7, s[40:43], s78 offen offset:1024 lds
    ds_read_b32 v27, v157 offset:64
    s_waitcnt lgkmcnt(6)
    v_mfma_f32_32x32x16_bf16 a[32:47], a[16:19], v[22:25], a[32:47]
    s_waitcnt lgkmcnt(0)
    ds_write_b32 v158, v159 offset:80
    v_cmp_gt_u32 vcc, 4, v27
    s_nop 0
    s_cbranch_vccnz Lvp22
Lvk23:
    ds_read_b64_tr_b16 a[0:1], v18 offset:0
    ds_read_b64_tr_b16 a[2:3], v18 offset:1024
    ds_read_b128 a[8:11], v10 offset:0
    v_mfma_f32_32x32x16_bf16 v[32:47], a[16:19], a[24:27], v[32:47]
    ds_read_b128 a[12:15], v10 offset:4096
    ds_read_b64_tr_b16 a[4:5], v19 offset:0
    ds_read_b64_tr_b16 a[6:7], v19 offset:1024
    v_mfma_f32_32x32x16_bf16 v[48:63], a[16:19], a[28:31], v[48:63]
    buffer_load_dwordx4 v8, s[40:43], s78 offen offset:2048 lds
    v_mfma_f32_32x32x16_bf16 v[64:79], a[20:23], a[24:27], v[64:79]
    v_mfma_f32_32x32x16_bf16 v[80:95], a[20:23], a[28:31], v[80:95]
    buffer_load_dwordx4 v9, s[40:43], s78 offen offset:3072 lds
    s_waitcnt lgkmcnt(4)
    v_mfma_f32_32x32x16_bf16 a[32:47], a[0:3], v[22:25], a[32:47]
    ds_read_b32 v27, v157 offset:80
    ds_read_b64_tr_b16 a[16:17], v18 offset:4096
    ds_read_b64_tr_b16 a[18:19], v18 offset:5120
    s_waitcnt lgkmcnt(6)
    v_mfma_f32_32x32x16_bf16 v[32:47], a[0:3], a[8:11], v[32:47]
    ds_read_b128 a[24:27], v11 offset:0
    ds_read_b128 a[28:31], v11 offset:4096
    s_waitcnt lgkmcnt(7)
    v_mfma_f32_32x32x16_bf16 v[48:63], a[0:3], a[12:15], v[48:63]
    s_waitcnt lgkmcnt(4)
    v_cmp_gt_u32 vcc, 4, v27
    s_nop 0
    s_cbranch_vccnz Lvp25
Lvk26:
    s_add_u32 m0, s68, 98304
    s_and_b32 s101, s69, 1
    s_lshl2_add_u32 s101, s101, 7
    s_and_b32 s101, s101, 7
    s_lshl_b32 s78, s101, 7
    s_add_u32 s78, s78, s66
    buffer_load_dwordx4 v2, s[36:39], s78 offen offset:0 lds
    ds_read_b64_tr_b16 a[20:21], v19 offset:4096
    ds_read_b64_tr_b16 a[22:23], v19 offset:5120
    v_mfma_f32_32x32x16_bf16 v[64:79], a[4:7], a[8:11], v[64:79]
    v_mfma_f32_32x32x16_bf16 v[80:95], a[4:7], a[12:15], v[80:95]
    buffer_load_dwordx4 v3, s[36:39], s78 offen offset:1024 lds
    s_waitcnt lgkmcnt(4)
    v_mfma_f32_32x32x16_bf16 a[32:47], a[16:19], v[22:25], a[32:47]
    ds_read_b64_tr_b16 a[0:1], v18 offset:8192
    ds_read_b64_tr_b16 a[2:3], v18 offset:9216
    s_waitcnt lgkmcnt(5)
    v_mfma_f32_32x32x16_bf16 v[32:47], a[16:19], a[24:27], v[32:47]
    ds_read_b128 a[8:11], v12 offset:0
    ds_read_b128 a[12:15], v12 offset:4096
    buffer_load_dwordx4 v4, s[36:39], s78 offen offset:2048 lds
    s_waitcnt lgkmcnt(6)
    v_mfma_f32_32x32x16_bf16 v[48:63], a[16:19], a[28:31], v[48:63]
    ds_read_b64_tr_b16 a[4:5], v19 offset:8192
    ds_read_b64_tr_b16 a[6:7], v19 offset:9216
    s_waitcnt lgkmcnt(6)
    v_mfma_f32_32x32x16_bf16 v[64:79], a[20:23], a[24:27], v[64:79]
    v_mfma_f32_32x32x16_bf16 v[80:95], a[20:23], a[28:31], v[80:95]
    buffer_load_dwordx4 v5, s[36:39], s78 offen offset:3072 lds
    s_waitcnt lgkmcnt(4)
    v_mfma_f32_32x32x16_bf16 a[32:47], a[0:3], v[22:25], a[32:47]
    v_mov_b32 v159, 5
    ds_read_b64_tr_b16 a[16:17], v18 offset:12288
    ds_read_b64_tr_b16 a[18:19], v18 offset:13312
    s_waitcnt lgkmcnt(5)
    v_mfma_f32_32x32x16_bf16 v[32:47], a[0:3], a[8:11], v[32:47]
    s_waitcnt vmcnt(12)
    ds_write_b32 v158, v159 offset:64
    ds_read_b128 a[24:27], v13 offset:0
    ds_read_b128 a[28:31], v13 offset:4096
    s_waitcnt lgkmcnt(7)
    v_mfma_f32_32x32x16_bf16 v[48:63], a[0:3], a[12:15], v[48:63]
    ds_read_b64_tr_b16 a[20:21], v19 offset:12288
    ds_read_b64_tr_b16 a[22:23], v19 offset:13312
    s_waitcnt lgkmcnt(7)
    v_mfma_f32_32x32x16_bf16 v[64:79], a[4:7], a[8:11], v[64:79]
    s_add_u32 m0, s68, 114688
    s_mul_i32 s78, s101, 229376
    s_add_u32 s78, s78, s67
    buffer_load_dwordx4 v6, s[40:43], s78 offen offset:0 lds
    v_mfma_f32_32x32x16_bf16 v[80:95], a[4:7], a[12:15], v[80:95]
    buffer_load_dwordx4 v7, s[40:43], s78 offen offset:1024 lds
    ds_read_b32 v27, v157 offset:64
    s_waitcnt lgkmcnt(6)
    v_mfma_f32_32x32x16_bf16 a[32:47], a[16:19], v[22:25], a[32:47]
    s_waitcnt lgkmcnt(0)
    ds_write_b32 v158, v159 offset:80
    v_cmp_gt_u32 vcc, 5, v27
    s_nop 0
    s_cbranch_vccnz Lvp28
Lvk29:
    ds_read_b64_tr_b16 a[0:1], v18 offset:32768
    ds_read_b64_tr_b16 a[2:3], v18 offset:33792
    ds_read_b128 a[8:11], v10 offset:32768
    v_mfma_f32_32x32x16_bf16 v[32:47], a[16:19], a[24:27], v[32:47]
    ds_read_b128 a[12:15], v10 offset:36864
    ds_read_b64_tr_b16 a[4:5], v19 offset:32768
    ds_read_b64_tr_b16 a[6:7], v19 offset:33792
    v_mfma_f32_32x32x16_bf16 v[48:63], a[16:19], a[28:31], v[48:63]
    buffer_load_dwordx4 v8, s[40:43], s78 offen offset:2048 lds
    v_mfma_f32_32x32x16_bf16 v[64:79], a[20:23], a[24:27], v[64:79]
    v_mfma_f32_32x32x16_bf16 v[80:95], a[20:23], a[28:31], v[80:95]
    buffer_load_dwordx4 v9, s[40:43], s78 offen offset:3072 lds
    s_waitcnt lgkmcnt(4)
    v_mfma_f32_32x32x16_bf16 a[32:47], a[0:3], v[22:25], a[32:47]
    ds_read_b32 v27, v157 offset:80
    ds_read_b64_tr_b16 a[16:17], v18 offset:36864
    ds_read_b64_tr_b16 a[18:19], v18 offset:37888
    s_waitcnt lgkmcnt(6)
    v_mfma_f32_32x32x16_bf16 v[32:47], a[0:3], a[8:11], v[32:47]
    ds_read_b128 a[24:27], v11 offset:32768
    ds_read_b128 a[28:31], v11 offset:36864
    s_waitcnt lgkmcnt(7)
    v_mfma_f32_32x32x16_bf16 v[48:63], a[0:3], a[12:15], v[48:63]
    s_waitcnt lgkmcnt(4)
    v_cmp_gt_u32 vcc, 5, v27
    s_nop 0
    s_cbranch_vccnz Lvp31
Lvk32:
    s_add_u32 m0, s77, 0
    s_nop 0
    buffer_load_dwordx4 v0, s[44:47], s76 offen offset:0 lds
    ds_read_b64_tr_b16 a[20:21], v19 offset:36864
    ds_read_b64_tr_b16 a[22:23], v19 offset:37888
    v_mfma_f32_32x32x16_bf16 v[64:79], a[4:7], a[8:11], v[64:79]
    v_mfma_f32_32x32x16_bf16 v[80:95], a[4:7], a[12:15], v[80:95]
    buffer_load_dwordx4 v148, s[44:47], s76 offen offset:1024 lds
    s_waitcnt lgkmcnt(4)
    v_mfma_f32_32x32x16_bf16 a[32:47], a[16:19], v[22:25], a[32:47]
    ds_read_b64_tr_b16 a[0:1], v18 offset:40960
    ds_read_b64_tr_b16 a[2:3], v18 offset:41984
    s_waitcnt lgkmcnt(5)
    v_mfma_f32_32x32x16_bf16 v[32:47], a[16:19], a[24:27], v[32:47]
    ds_read_b128 a[8:11], v12 offset:32768
    ds_read_b128 a[12:15], v12 offset:36864
    buffer_load_dwordx4 v149, s[44:47], s76 offen offset:2048 lds
    s_waitcnt lgkmcnt(6)
    v_mfma_f32_32x32x16_bf16 v[48:63], a[16:19], a[28:31], v[48:63]
    ds_read_b64_tr_b16 a[4:5], v19 offset:40960
    ds_read_b64_tr_b16 a[6:7], v19 offset:41984
    s_waitcnt lgkmcnt(6)
    v_mfma_f32_32x32x16_bf16 v[64:79], a[20:23], a[24:27], v[64:79]
    v_mfma_f32_32x32x16_bf16 v[80:95], a[20:23], a[28:31], v[80:95]
    buffer_load_dwordx4 v150, s[44:47], s76 offen offset:3072 lds
    s_waitcnt lgkmcnt(4)
    v_mfma_f32_32x32x16_bf16 a[32:47], a[0:3], v[22:25], a[32:47]
    v_mov_b32 v159, 6
    ds_read_b64_tr_b16 a[16:17], v18 offset:45056
    ds_read_b64_tr_b16 a[18:19], v18 offset:46080
    s_waitcnt lgkmcnt(5)
    v_mfma_f32_32x32x16_bf16 v[32:47], a[0:3], a[8:11], v[32:47]
    s_waitcnt vmcnt(12)
    ds_write_b32 v158, v159 offset:64
    ds_read_b128 a[24:27], v13 offset:32768
    ds_read_b128 a[28:31], v13 offset:36864
    s_waitcnt lgkmcnt(7)
    v_mfma_f32_32x32x16_bf16 v[48:63], a[0:3], a[12:15], v[48:63]
    ds_read_b64_tr_b16 a[20:21], v19 offset:45056
    ds_read_b64_tr_b16 a[22:23], v19 offset:46080
    s_waitcnt lgkmcnt(7)
    v_mfma_f32_32x32x16_bf16 v[64:79], a[4:7], a[8:11], v[64:79]
    s_add_u32 m0, s77, 4096
    s_add_u32 s78, s76, 32768
    buffer_load_dwordx4 v0, s[44:47], s78 offen offset:0 lds
    v_mfma_f32_32x32x16_bf16 v[80:95], a[4:7], a[12:15], v[80:95]
    buffer_load_dwordx4 v148, s[44:47], s78 offen offset:1024 lds
    ds_read_b32 v27, v157 offset:64
    buffer_load_dwordx4 v[2:5], v153, s[48:51], 0 offen offset:0 sc1
    buffer_load_dwordx4 v[6:9], v153, s[48:51], 0 offen offset:512 sc1
    s_waitcnt lgkmcnt(6)
    v_mfma_f32_32x32x16_bf16 a[32:47], a[16:19], v[22:25], a[32:47]
    s_waitcnt lgkmcnt(0)
    ds_write_b32 v158, v159 offset:80
    v_cmp_gt_u32 vcc, 6, v27
    s_nop 0
    s_cbranch_vccnz Lvp34
Lvk35:
    ds_read_b64_tr_b16 a[0:1], v20 offset:0
    ds_read_b64_tr_b16 a[2:3], v20 offset:1024
    ds_read_b128 a[8:11], v14 offset:0
    v_mfma_f32_32x32x16_bf16 v[32:47], a[16:19], a[24:27], v[32:47]
    ds_read_b128 a[12:15], v14 offset:4096
    ds_read_b64_tr_b16 a[4:5], v21 offset:0
    ds_read_b64_tr_b16 a[6:7], v21 offset:1024
    v_mfma_f32_32x32x16_bf16 v[48:63], a[16:19], a[28:31], v[48:63]
    buffer_load_dwordx4 v149, s[44:47], s78 offen offset:2048 lds
    v_mfma_f32_32x32x16_bf16 v[64:79], a[20:23], a[24:27], v[64:79]
    v_mfma_f32_32x32x16_bf16 v[80:95], a[20:23], a[28:31], v[80:95]
    buffer_load_dwordx4 v150, s[44:47], s78 offen offset:3072 lds
    s_waitcnt lgkmcnt(4)
    v_mfma_f32_32x32x16_bf16 a[32:47], a[0:3], v[22:25], a[32:47]
    ds_read_b32 v27, v157 offset:80
    ds_read_b64_tr_b16 a[16:17], v20 offset:4096
    ds_read_b64_tr_b16 a[18:19], v20 offset:5120
    s_waitcnt lgkmcnt(6)
    v_mfma_f32_32x32x16_bf16 v[32:47], a[0:3], a[8:11], v[32:47]
    ds_read_b128 a[24:27], v15 offset:0
    ds_read_b128 a[28:31], v15 offset:4096
    s_waitcnt lgkmcnt(7)
    v_mfma_f32_32x32x16_bf16 v[48:63], a[0:3], a[12:15], v[48:63]
    s_waitcnt lgkmcnt(4)
    v_cmp_gt_u32 vcc, 6, v27
    s_nop 0
    s_cbranch_vccnz Lvp37
Lvk38:
    s_add_u32 s76, s76, 65536
    s_cmp_eq_u32 s76, s35
    s_cselect_b32 s76, s34, s76
    s_add_u32 m0, s77, 32768
    s_nop 0
    buffer_load_dwordx4 v0, s[44:47], s76 offen offset:0 lds
    ds_read_b64_tr_b16 a[20:21], v21 offset:4096
    ds_read_b64_tr_b16 a[22:23], v21 offset:5120
    v_mfma_f32_32x32x16_bf16 v[64:79], a[4:7], a[8:11], v[64:79]
    v_mfma_f32_32x32x16_bf16 v[80:95], a[4:7], a[12:15], v[80:95]
    buffer_load_dwordx4 v148, s[44:47], s76 offen offset:1024 lds
    s_waitcnt lgkmcnt(4)
    v_mfma_f32_32x32x16_bf16 a[32:47], a[16:19], v[22:25], a[32:47]
    ds_read_b64_tr_b16 a[0:1], v20 offset:8192
    ds_read_b64_tr_b16 a[2:3], v20 offset:9216
    s_waitcnt lgkmcnt(5)
    v_mfma_f32_32x32x16_bf16 v[32:47], a[16:19], a[24:27], v[32:47]
    ds_read_b128 a[8:11], v16 offset:0
    ds_read_b128 a[12:15], v16 offset:4096
    buffer_load_dwordx4 v149, s[44:47], s76 offen offset:2048 lds
    s_waitcnt lgkmcnt(6)
    v_mfma_f32_32x32x16_bf16 v[48:63], a[16:19], a[28:31], v[48:63]
    ds_read_b64_tr_b16 a[4:5], v21 offset:8192
    ds_read_b64_tr_b16 a[6:7], v21 offset:9216
    s_waitcnt lgkmcnt(6)
    v_mfma_f32_32x32x16_bf16 v[64:79], a[20:23], a[24:27], v[64:79]
    v_mfma_f32_32x32x16_bf16 v[80:95], a[20:23], a[28:31], v[80:95]
    buffer_load_dwordx4 v150, s[44:47], s76 offen offset:3072 lds
    s_waitcnt lgkmcnt(4)
    v_mfma_f32_32x32x16_bf16 a[32:47], a[0:3], v[22:25], a[32:47]
    v_mov_b32 v159, 7
    ds_read_b64_tr_b16 a[16:17], v20 offset:12288
    ds_read_b64_tr_b16 a[18:19], v20 offset:13312
    s_waitcnt lgkmcnt(5)
    v_mfma_f32_32x32x16_bf16 v[32:47], a[0:3], a[8:11], v[32:47]
    s_waitcnt vmcnt(14)
    ds_write_b32 v158, v159 offset:64
    ds_read_b128 a[24:27], v17 offset:0
    ds_read_b128 a[28:31], v17 offset:4096
    s_waitcnt lgkmcnt(7)
    v_mfma_f32_32x32x16_bf16 v[48:63], a[0:3], a[12:15], v[48:63]
    ds_read_b64_tr_b16 a[20:21], v21 offset:12288
    ds_read_b64_tr_b16 a[22:23], v21 offset:13312
    s_waitcnt lgkmcnt(7)
    v_mfma_f32_32x32x16_bf16 v[64:79], a[4:7], a[8:11], v[64:79]
    s_add_u32 m0, s77, 36864
    s_add_u32 s78, s76, 32768
    buffer_load_dwordx4 v0, s[44:47], s78 offen offset:0 lds
    v_mfma_f32_32x32x16_bf16 v[80:95], a[4:7], a[12:15], v[80:95]
    buffer_load_dwordx4 v148, s[44:47], s78 offen offset:1024 lds
    ds_read_b32 v27, v157 offset:64
    s_waitcnt lgkmcnt(6)
    v_mfma_f32_32x32x16_bf16 a[32:47], a[16:19], v[22:25], a[32:47]
    s_waitcnt lgkmcnt(0)
    ds_write_b32 v158, v159 offset:80
    v_cmp_gt_u32 vcc, 7, v27
    s_nop 0
    s_cbranch_vccnz Lvp40
Lvk41:
    ds_read_b64_tr_b16 a[0:1], v20 offset:32768
    ds_read_b64_tr_b16 a[2:3], v20 offset:33792
    ds_read_b128 a[8:11], v14 offset:32768
    v_mfma_f32_32x32x16_bf16 v[32:47], a[16:19], a[24:27], v[32:47]
    ds_read_b128 a[12:15], v14 offset:36864
    ds_read_b64_tr_b16 a[4:5], v21 offset:32768
    ds_read_b64_tr_b16 a[6:7], v21 offset:33792
    v_mfma_f32_32x32x16_bf16 v[48:63], a[16:19], a[28:31], v[48:63]
    buffer_load_dwordx4 v149, s[44:47], s78 offen offset:2048 lds
    v_mfma_f32_32x32x16_bf16 v[64:79], a[20:23], a[24:27], v[64:79]
    v_mfma_f32_32x32x16_bf16 v[80:95], a[20:23], a[28:31], v[80:95]
    buffer_load_dwordx4 v150, s[44:47], s78 offen offset:3072 lds
    s_waitcnt lgkmcnt(4)
    v_mfma_f32_32x32x16_bf16 a[32:47], a[0:3], v[22:25], a[32:47]
    ds_read_b32 v27, v157 offset:80
    ds_read_b64_tr_b16 a[16:17], v20 offset:36864
    ds_read_b64_tr_b16 a[18:19], v20 offset:37888
    s_waitcnt lgkmcnt(6)
    v_mfma_f32_32x32x16_bf16 v[32:47], a[0:3], a[8:11], v[32:47]
    ds_read_b128 a[24:27], v15 offset:32768
    ds_read_b128 a[28:31], v15 offset:36864
    s_waitcnt lgkmcnt(7)
    v_mfma_f32_32x32x16_bf16 v[48:63], a[0:3], a[12:15], v[48:63]
    s_waitcnt lgkmcnt(4)
    v_cmp_gt_u32 vcc, 7, v27
    s_nop 0
    s_cbranch_vccnz Lvp43
Lvk44:
    s_add_u32 s76, s76, 65536
    s_cmp_eq_u32 s76, s35
    s_cselect_b32 s76, s34, s76
    s_add_u32 m0, s77, 65536
    s_nop 0
    buffer_load_dwordx4 v0, s[44:47], s76 offen offset:0 lds
    ds_read_b64_tr_b16 a[20:21], v21 offset:36864
    ds_read_b64_tr_b16 a[22:23], v21 offset:37888
    v_mfma_f32_32x32x16_bf16 v[64:79], a[4:7], a[8:11], v[64:79]
    v_mfma_f32_32x32x16_bf16 v[80:95], a[4:7], a[12:15], v[80:95]
    buffer_load_dwordx4 v148, s[44:47], s76 offen offset:1024 lds
    s_waitcnt lgkmcnt(4)
    v_mfma_f32_32x32x16_bf16 a[32:47], a[16:19], v[22:25], a[32:47]
    ds_read_b64_tr_b16 a[0:1], v20 offset:40960
    ds_read_b64_tr_b16 a[2:3], v20 offset:41984
    s_waitcnt lgkmcnt(5)
    v_mfma_f32_32x32x16_bf16 v[32:47], a[16:19], a[24:27], v[32:47]
    ds_read_b128 a[8:11], v16 offset:32768
    ds_read_b128 a[12:15], v16 offset:36864
    buffer_load_dwordx4 v149, s[44:47], s76 offen offset:2048 lds
    s_waitcnt lgkmcnt(6)
    v_mfma_f32_32x32x16_bf16 v[48:63], a[16:19], a[28:31], v[48:63]
    ds_read_b64_tr_b16 a[4:5], v21 offset:40960
    ds_read_b64_tr_b16 a[6:7], v21 offset:41984
    s_waitcnt lgkmcnt(6)
    v_mfma_f32_32x32x16_bf16 v[64:79], a[20:23], a[24:27], v[64:79]
    v_mfma_f32_32x32x16_bf16 v[80:95], a[20:23], a[28:31], v[80:95]
    buffer_load_dwordx4 v150, s[44:47], s76 offen offset:3072 lds
    s_waitcnt lgkmcnt(4)
    v_mfma_f32_32x32x16_bf16 a[32:47], a[0:3], v[22:25], a[32:47]
    ds_read_b64_tr_b16 a[16:17], v20 offset:45056
    ds_read_b64_tr_b16 a[18:19], v20 offset:46080
    s_waitcnt lgkmcnt(5)
    v_mfma_f32_32x32x16_bf16 v[32:47], a[0:3], a[8:11], v[32:47]
    ds_read_b128 a[24:27], v17 offset:32768
    ds_read_b128 a[28:31], v17 offset:36864
    s_waitcnt lgkmcnt(6)
    v_mfma_f32_32x32x16_bf16 v[48:63], a[0:3], a[12:15], v[48:63]
    ds_read_b64_tr_b16 a[20:21], v21 offset:45056
    ds_read_b64_tr_b16 a[22:23], v21 offset:46080
    s_waitcnt lgkmcnt(6)
    v_mfma_f32_32x32x16_bf16 v[64:79], a[4:7], a[8:11], v[64:79]
    s_add_u32 m0, s77, 69632
    s_add_u32 s78, s76, 32768
    buffer_load_dwordx4 v0, s[44:47], s78 offen offset:0 lds
    v_mfma_f32_32x32x16_bf16 v[80:95], a[4:7], a[12:15], v[80:95]
    buffer_load_dwordx4 v148, s[44:47], s78 offen offset:1024 lds
    s_waitcnt lgkmcnt(4)
    v_mfma_f32_32x32x16_bf16 a[32:47], a[16:19], v[22:25], a[32:47]
    s_waitcnt lgkmcnt(3)
    v_mfma_f32_32x32x16_bf16 v[32:47], a[16:19], a[24:27], v[32:47]
    s_waitcnt lgkmcnt(2)
    v_mfma_f32_32x32x16_bf16 v[48:63], a[16:19], a[28:31], v[48:63]
    v_mov_b32 v159, 8
    s_mov_b32 exec_lo, 1
    s_mov_b32 exec_hi, 1
    s_nop 4
    ds_write_b128 v26, a[32:35] offset:0
    ds_write_b128 v26, a[36:39] offset:32
    ds_write_b128 v26, a[40:43] offset:64
    ds_write_b128 v26, a[44:47] offset:96
    s_mov_b64 exec, -1
    ds_write_b32 v158, v159 offset:80
    ds_read_b128 v[96:99], v26 offset:0
    ds_read_b128 v[100:103], v26 offset:32
    ds_read_b128 v[104:107], v26 offset:64
    ds_read_b128 v[108:111], v26 offset:96
    buffer_load_dwordx4 v149, s[44:47], s78 offen offset:2048 lds
    s_waitcnt lgkmcnt(9)
    v_mfma_f32_32x32x16_bf16 v[64:79], a[20:23], a[24:27], v[64:79]
    v_mfma_f32_32x32x16_bf16 v[80:95], a[20:23], a[28:31], v[80:95]
    buffer_load_dwordx4 v150, s[44:47], s78 offen offset:3072 lds
    ds_read_b32 v27, v157 offset:80
    s_waitcnt lgkmcnt(0)
    v_cmp_gt_u32 vcc, 8, v27
    s_nop 0
    s_cbranch_vccnz Lvp46
Lvk47:
    s_waitcnt vmcnt(19)
    v_cmp_ne_u32 vcc, s60, v4
    s_waitcnt vmcnt(18)
    v_cmp_ne_u32 s[74:75], s60, v8
    s_nop 0
    s_or_b64 vcc, vcc, s[74:75]
    s_cbranch_vccnz Lgs49
Lgk50:
    v_mov_b32 v4, v3
    v_mov_b32 v5, v3
    v_mov_b32 v3, v2
    v_mov_b32 v8, v7
    v_mov_b32 v9, v7
    v_mov_b32 v7, v6
    v_mov_b32 v153, v158
    v_pk_fma_f32 v[10:11], v[96:97], v[4:5], v[112:113]
    s_add_u32 s76, s76, 65536
    s_cmp_eq_u32 s76, s35
    s_cselect_b32 s76, s34, s76
    s_add_u32 m0, s77, 98304
    s_nop 0
    buffer_load_dwordx4 v0, s[44:47], s76 offen offset:0 lds
    v_pk_fma_f32 v[12:13], v[98:99], v[4:5], v[114:115]
    buffer_load_dwordx4 v148, s[44:47], s76 offen offset:1024 lds
    v_pk_fma_f32 v[14:15], v[100:101], v[4:5], v[116:117]
    v_pk_fma_f32 v[16:17], v[102:103], v[4:5], v[118:119]
    buffer_load_dwordx4 v149, s[44:47], s76 offen offset:2048 lds
    v_pk_fma_f32 v[32:33], v[32:33], v[2:3], v[10:11]
    v_pk_fma_f32 v[34:35], v[34:35], v[2:3], v[12:13]
    buffer_load_dwordx4 v150, s[44:47], s76 offen offset:3072 lds
    v_pk_fma_f32 v[36:37], v[36:37], v[2:3], v[14:15]
    s_waitcnt vmcnt(20)
    ds_read_b64_tr_b16 a[0:1], v144 offset:0
    ds_read_b64_tr_b16 a[2:3], v144 offset:1024
    v_pk_fma_f32 v[38:39], v[38:39], v[2:3], v[16:17]
    v_pk_mul_f32 v[10:11], v[32:33], v[32:33]
    ds_read_b64_tr_b16 a[4:5], v145 offset:0
    ds_read_b64_tr_b16 a[6:7], v145 offset:1024
    v_pk_mul_f32 v[12:13], v[34:35], v[34:35]
    v_pk_mul_f32 v[14:15], v[36:37], v[36:37]
    ds_read_b64_tr_b16 a[8:9], v144 offset:2048
    ds_read_b64_tr_b16 a[10:11], v144 offset:3072
    v_pk_mul_f32 v[16:17], v[38:39], v[38:39]
    ds_read_b64_tr_b16 a[12:13], v145 offset:2048
    ds_read_b64_tr_b16 a[14:15], v145 offset:3072
    v_pk_fma_f32 v[10:11], v[10:11], v[30:31], s[4:5]
    v_pk_fma_f32 v[12:13], v[12:13], v[30:31], s[4:5]
    ds_read_b64_tr_b16 a[16:17], v144 offset:4096
    ds_read_b64_tr_b16 a[18:19], v144 offset:5120
    v_pk_fma_f32 v[14:15], v[14:15], v[30:31], s[4:5]
    v_pk_fma_f32 v[16:17], v[16:17], v[30:31], s[4:5]
    ds_read_b64_tr_b16 a[20:21], v145 offset:4096
    ds_read_b64_tr_b16 a[22:23], v145 offset:5120
    v_pk_mul_f32 v[10:11], v[10:11], v[32:33]
    ds_read_b64_tr_b16 a[24:25], v144 offset:6144
    ds_read_b64_tr_b16 a[26:27], v144 offset:7168
    v_pk_mul_f32 v[12:13], v[12:13], v[34:35]
    v_pk_mul_f32 v[14:15], v[14:15], v[36:37]
    ds_read_b64_tr_b16 a[28:29], v145 offset:6144
    ds_read_b64_tr_b16 a[30:31], v145 offset:7168
    v_pk_mul_f32 v[16:17], v[16:17], v[38:39]
    v_exp_f32 v10, v10
    v_pk_fma_f32 v[18:19], v[104:105], v[4:5], v[120:121]
    v_exp_f32 v11, v11
    v_pk_fma_f32 v[20:21], v[106:107], v[4:5], v[122:123]
    v_exp_f32 v12, v12
    v_pk_fma_f32 v[22:23], v[108:109], v[4:5], v[124:125]
    v_exp_f32 v13, v13
    v_pk_fma_f32 v[24:25], v[110:111], v[4:5], v[126:127]
    v_exp_f32 v14, v14
    v_pk_fma_f32 v[40:41], v[40:41], v[2:3], v[18:19]
    v_exp_f32 v15, v15
    v_pk_fma_f32 v[42:43], v[42:43], v[2:3], v[20:21]
    v_exp_f32 v16, v16
    v_pk_fma_f32 v[44:45], v[44:45], v[2:3], v[22:23]
    v_exp_f32 v17, v17
    v_pk_fma_f32 v[46:47], v[46:47], v[2:3], v[24:25]
    v_pk_add_f32 v[10:11], v[10:11], s[6:7]
    v_pk_add_f32 v[12:13], v[12:13], s[6:7]
    v_pk_add_f32 v[14:15], v[14:15], s[6:7]
    v_pk_add_f32 v[16:17], v[16:17], s[6:7]
    v_rcp_f32 v10, v10
    v_pk_mul_f32 v[18:19], v[40:41], v[40:41]
    v_rcp_f32 v11, v11
    v_pk_mul_f32 v[20:21], v[42:43], v[42:43]
    v_pk_mul_f32 v[22:23], v[44:45], v[44:45]
    v_rcp_f32 v12, v12
    v_pk_mul_f32 v[24:25], v[46:47], v[46:47]
    v_rcp_f32 v13, v13
    v_pk_fma_f32 v[18:19], v[18:19], v[30:31], s[4:5]
    v_pk_fma_f32 v[20:21], v[20:21], v[30:31], s[4:5]
    v_rcp_f32 v14, v14
    v_pk_fma_f32 v[22:23], v[22:23], v[30:31], s[4:5]
    v_rcp_f32 v15, v15
    v_pk_fma_f32 v[24:25], v[24:25], v[30:31], s[4:5]
    v_pk_mul_f32 v[18:19], v[18:19], v[40:41]
    v_rcp_f32 v16, v16
    v_pk_mul_f32 v[20:21], v[20:21], v[42:43]
    v_rcp_f32 v17, v17
    v_pk_mul_f32 v[22:23], v[22:23], v[44:45]
    v_pk_mul_f32 v[24:25], v[24:25], v[46:47]
    v_exp_f32 v18, v18
    v_pk_mul_f32 v[32:33], v[32:33], v[10:11]
    v_pk_mul_f32 v[34:35], v[34:35], v[12:13]
    v_exp_f32 v19, v19
    v_pk_mul_f32 v[36:37], v[36:37], v[14:15]
    v_pk_mul_f32 v[38:39], v[38:39], v[16:17]
    v_exp_f32 v20, v20
    v_cvt_pk_bf16_f32 v32, v32, v33
    v_cvt_pk_bf16_f32 v33, v34, v35
    v_exp_f32 v21, v21
    v_cvt_pk_bf16_f32 v34, v36, v37
    v_cvt_pk_bf16_f32 v35, v38, v39
    v_exp_f32 v22, v22
    buffer_store_dwordx4 v[32:35], v29, s[48:51], s70 offen offset:0 sc1
    v_pk_fma_f32 v[154:155], v[96:97], v[8:9], v[112:113]
    v_exp_f32 v23, v23
    v_pk_fma_f32 v[156:157], v[98:99], v[8:9], v[114:115]
    v_pk_fma_f32 v[158:159], v[100:101], v[8:9], v[116:117]
    v_exp_f32 v24, v24
    v_pk_fma_f32 v[26:27], v[102:103], v[8:9], v[118:119]
    v_pk_fma_f32 v[48:49], v[48:49], v[6:7], v[154:155]
    v_exp_f32 v25, v25
    v_pk_fma_f32 v[50:51], v[50:51], v[6:7], v[156:157]
    v_pk_fma_f32 v[52:53], v[52:53], v[6:7], v[158:159]
    v_pk_fma_f32 v[54:55], v[54:55], v[6:7], v[26:27]
    v_pk_add_f32 v[18:19], v[18:19], s[6:7]
    v_pk_add_f32 v[20:21], v[20:21], s[6:7]
    v_pk_add_f32 v[22:23], v[22:23], s[6:7]
    v_pk_add_f32 v[24:25], v[24:25], s[6:7]
    v_rcp_f32 v18, v18
    v_pk_mul_f32 v[154:155], v[48:49], v[48:49]
    v_rcp_f32 v19, v19
    v_pk_mul_f32 v[156:157], v[50:51], v[50:51]
    v_pk_mul_f32 v[158:159], v[52:53], v[52:53]
    v_rcp_f32 v20, v20
    v_pk_mul_f32 v[26:27], v[54:55], v[54:55]
    v_rcp_f32 v21, v21
    v_pk_fma_f32 v[154:155], v[154:155], v[30:31], s[4:5]
    v_pk_fma_f32 v[156:157], v[156:157], v[30:31], s[4:5]
    v_rcp_f32 v22, v22
    v_pk_fma_f32 v[158:159], v[158:159], v[30:31], s[4:5]
    v_rcp_f32 v23, v23
    v_pk_fma_f32 v[26:27], v[26:27], v[30:31], s[4:5]
    v_pk_mul_f32 v[154:155], v[154:155], v[48:49]
    v_rcp_f32 v24, v24
    v_pk_mul_f32 v[156:157], v[156:157], v[50:51]
    v_rcp_f32 v25, v25
    v_pk_mul_f32 v[158:159], v[158:159], v[52:53]
    v_pk_mul_f32 v[26:27], v[26:27], v[54:55]
    v_exp_f32 v154, v154
    v_pk_mul_f32 v[40:41], v[40:41], v[18:19]
    v_pk_mul_f32 v[42:43], v[42:43], v[20:21]
    s_waitcnt vmcnt(13)
    ds_read_b64_tr_b16 a[32:33], v144 offset:32768
    ds_read_b64_tr_b16 a[34:35], v144 offset:33792
    v_exp_f32 v155, v155
    v_pk_mul_f32 v[44:45], v[44:45], v[22:23]
    v_pk_mul_f32 v[46:47], v[46:47], v[24:25]
    v_exp_f32 v156, v156
    v_cvt_pk_bf16_f32 v40, v40, v41
    v_cvt_pk_bf16_f32 v41, v42, v43
    ds_read_b64_tr_b16 a[36:37], v145 offset:32768
    ds_read_b64_tr_b16 a[38:39], v145 offset:33792
    v_exp_f32 v157, v157
    v_cvt_pk_bf16_f32 v42, v44, v45
    v_cvt_pk_bf16_f32 v43, v46, v47
    v_exp_f32 v158, v158
    buffer_store_dwordx4 v[40:43], v29, s[48:51], s70 offen offset:1024 sc1
    v_pk_fma_f32 v[10:11], v[104:105], v[8:9], v[120:121]
    ds_read_b64_tr_b16 a[40:41], v144 offset:34816
    ds_read_b64_tr_b16 a[42:43], v144 offset:35840
    v_exp_f32 v159, v159
    v_pk_fma_f32 v[12:13], v[106:107], v[8:9], v[122:123]
    v_pk_fma_f32 v[14:15], v[108:109], v[8:9], v[124:125]
    v_exp_f32 v26, v26
    v_pk_fma_f32 v[16:17], v[110:111], v[8:9], v[126:127]
    v_pk_fma_f32 v[56:57], v[56:57], v[6:7], v[10:11]
    ds_read_b64_tr_b16 a[44:45], v145 offset:34816
    ds_read_b64_tr_b16 a[46:47], v145 offset:35840
    v_exp_f32 v27, v27
    v_pk_fma_f32 v[58:59], v[58:59], v[6:7], v[12:13]
    v_pk_fma_f32 v[60:61], v[60:61], v[6:7], v[14:15]
    v_pk_fma_f32 v[62:63], v[62:63], v[6:7], v[16:17]
    v_pk_add_f32 v[154:155], v[154:155], s[6:7]
    v_pk_add_f32 v[156:157], v[156:157], s[6:7]
    v_pk_add_f32 v[158:159], v[158:159], s[6:7]
    ds_read_b64_tr_b16 a[48:49], v144 offset:36864
    ds_read_b64_tr_b16 a[50:51], v144 offset:37888
    v_pk_add_f32 v[26:27], v[26:27], s[6:7]
    v_rcp_f32 v154, v154
    v_pk_mul_f32 v[10:11], v[56:57], v[56:57]
    v_rcp_f32 v155, v155
    v_pk_mul_f32 v[12:13], v[58:59], v[58:59]
    v_pk_mul_f32 v[14:15], v[60:61], v[60:61]
    ds_read_b64_tr_b16 a[52:53], v145 offset:36864
    ds_read_b64_tr_b16 a[54:55], v145 offset:37888
    v_rcp_f32 v156, v156
    v_pk_mul_f32 v[16:17], v[62:63], v[62:63]
    v_rcp_f32 v157, v157
    v_pk_fma_f32 v[10:11], v[10:11], v[30:31], s[4:5]
    v_pk_fma_f32 v[12:13], v[12:13], v[30:31], s[4:5]
    v_rcp_f32 v158, v158
    ds_read_b64_tr_b16 a[56:57], v144 offset:38912
    ds_read_b64_tr_b16 a[58:59], v144 offset:39936
    v_pk_fma_f32 v[14:15], v[14:15], v[30:31], s[4:5]
    v_rcp_f32 v159, v159
    v_pk_fma_f32 v[16:17], v[16:17], v[30:31], s[4:5]
    v_pk_mul_f32 v[10:11], v[10:11], v[56:57]
    v_rcp_f32 v26, v26
    v_pk_mul_f32 v[12:13], v[12:13], v[58:59]
    ds_read_b64_tr_b16 a[60:61], v145 offset:38912
    ds_read_b64_tr_b16 a[62:63], v145 offset:39936
    v_rcp_f32 v27, v27
    v_pk_mul_f32 v[14:15], v[14:15], v[60:61]
    v_pk_mul_f32 v[16:17], v[16:17], v[62:63]
    ds_read_b128 v[32:35], v28 offset:0
    ds_read_b128 v[36:39], v28 offset:32
    ds_read_b128 v[40:43], v28 offset:64
    ds_read_b128 v[44:47], v28 offset:96
    v_exp_f32 v10, v10
    v_pk_mul_f32 v[48:49], v[48:49], v[154:155]
    v_pk_mul_f32 v[50:51], v[50:51], v[156:157]
    v_exp_f32 v11, v11
    v_pk_mul_f32 v[52:53], v[52:53], v[158:159]
    v_pk_mul_f32 v[54:55], v[54:55], v[26:27]
    v_exp_f32 v12, v12
    v_cvt_pk_bf16_f32 v48, v48, v49
    v_cvt_pk_bf16_f32 v49, v50, v51
    v_exp_f32 v13, v13
    v_cvt_pk_bf16_f32 v50, v52, v53
    v_cvt_pk_bf16_f32 v51, v54, v55
    v_exp_f32 v14, v14
    buffer_store_dwordx4 v[48:51], v29, s[48:51], s71 offen offset:0 sc1
    s_waitcnt lgkmcnt(3)
    v_pk_fma_f32 v[18:19], v[32:33], v[4:5], v[128:129]
    v_exp_f32 v15, v15
    v_pk_fma_f32 v[20:21], v[34:35], v[4:5], v[130:131]
    s_waitcnt lgkmcnt(2)
    v_pk_fma_f32 v[22:23], v[36:37], v[4:5], v[132:133]
    v_exp_f32 v16, v16
    v_pk_fma_f32 v[24:25], v[38:39], v[4:5], v[134:135]
    v_pk_fma_f32 v[64:65], v[64:65], v[2:3], v[18:19]
    v_exp_f32 v17, v17
    v_pk_fma_f32 v[66:67], v[66:67], v[2:3], v[20:21]
    v_pk_fma_f32 v[68:69], v[68:69], v[2:3], v[22:23]
    v_pk_fma_f32 v[70:71], v[70:71], v[2:3], v[24:25]
    v_pk_add_f32 v[10:11], v[10:11], s[6:7]
    v_pk_add_f32 v[12:13], v[12:13], s[6:7]
    v_pk_add_f32 v[14:15], v[14:15], s[6:7]
    v_pk_add_f32 v[16:17], v[16:17], s[6:7]
    v_rcp_f32 v10, v10
    v_pk_mul_f32 v[18:19], v[64:65], v[64:65]
    v_rcp_f32 v11, v11
    v_pk_mul_f32 v[20:21], v[66:67], v[66:67]
    v_pk_mul_f32 v[22:23], v[68:69], v[68:69]
    v_rcp_f32 v12, v12
    v_pk_mul_f32 v[24:25], v[70:71], v[70:71]
    v_rcp_f32 v13, v13
    v_pk_fma_f32 v[18:19], v[18:19], v[30:31], s[4:5]
    v_pk_fma_f32 v[20:21], v[20:21], v[30:31], s[4:5]
    v_rcp_f32 v14, v14
    v_pk_fma_f32 v[22:23], v[22:23], v[30:31], s[4:5]
    v_rcp_f32 v15, v15
    v_pk_fma_f32 v[24:25], v[24:25], v[30:31], s[4:5]
    v_pk_mul_f32 v[18:19], v[18:19], v[64:65]
    v_rcp_f32 v16, v16
    v_pk_mul_f32 v[20:21], v[20:21], v[66:67]
    v_rcp_f32 v17, v17
    v_pk_mul_f32 v[22:23], v[22:23], v[68:69]
    v_pk_mul_f32 v[24:25], v[24:25], v[70:71]
    v_exp_f32 v18, v18
    v_pk_mul_f32 v[56:57], v[56:57], v[10:11]
    s_waitcnt vmcnt(7)
    ds_read_b64_tr_b16 a[64:65], v146 offset:0
    ds_read_b64_tr_b16 a[66:67], v146 offset:1024
    v_pk_mul_f32 v[58:59], v[58:59], v[12:13]
    v_exp_f32 v19, v19
    v_pk_mul_f32 v[60:61], v[60:61], v[14:15]
    v_pk_mul_f32 v[62:63], v[62:63], v[16:17]
    v_exp_f32 v20, v20
    ds_read_b64_tr_b16 a[68:69], v147 offset:0
    ds_read_b64_tr_b16 a[70:71], v147 offset:1024
    v_cvt_pk_bf16_f32 v56, v56, v57
    v_cvt_pk_bf16_f32 v57, v58, v59
    v_exp_f32 v21, v21
    v_cvt_pk_bf16_f32 v58, v60, v61
    v_cvt_pk_bf16_f32 v59, v62, v63
    ds_read_b64_tr_b16 a[72:73], v146 offset:2048
    ds_read_b64_tr_b16 a[74:75], v146 offset:3072
    v_exp_f32 v22, v22
    buffer_store_dwordx4 v[56:59], v29, s[48:51], s71 offen offset:1024 sc1
    s_waitcnt lgkmcnt(7)
    v_pk_fma_f32 v[154:155], v[40:41], v[4:5], v[136:137]
    v_exp_f32 v23, v23
    v_pk_fma_f32 v[156:157], v[42:43], v[4:5], v[138:139]
    ds_read_b64_tr_b16 a[76:77], v147 offset:2048
    ds_read_b64_tr_b16 a[78:79], v147 offset:3072
    s_waitcnt lgkmcnt(8)
    v_pk_fma_f32 v[158:159], v[44:45], v[4:5], v[140:141]
    v_exp_f32 v24, v24
    v_pk_fma_f32 v[26:27], v[46:47], v[4:5], v[142:143]
    v_pk_fma_f32 v[72:73], v[72:73], v[2:3], v[154:155]
    v_exp_f32 v25, v25
    ds_read_b64_tr_b16 a[80:81], v146 offset:4096
    ds_read_b64_tr_b16 a[82:83], v146 offset:5120
    v_pk_fma_f32 v[74:75], v[74:75], v[2:3], v[156:157]
    v_pk_fma_f32 v[76:77], v[76:77], v[2:3], v[158:159]
    v_pk_fma_f32 v[78:79], v[78:79], v[2:3], v[26:27]
    v_pk_add_f32 v[18:19], v[18:19], s[6:7]
    v_pk_add_f32 v[20:21], v[20:21], s[6:7]
    ds_read_b64_tr_b16 a[84:85], v147 offset:4096
    ds_read_b64_tr_b16 a[86:87], v147 offset:5120
    v_pk_add_f32 v[22:23], v[22:23], s[6:7]
    v_pk_add_f32 v[24:25], v[24:25], s[6:7]
    v_rcp_f32 v18, v18
    v_pk_mul_f32 v[154:155], v[72:73], v[72:73]
    v_rcp_f32 v19, v19
    ds_read_b64_tr_b16 a[88:89], v146 offset:6144
    ds_read_b64_tr_b16 a[90:91], v146 offset:7168
    v_pk_mul_f32 v[156:157], v[74:75], v[74:75]
    v_pk_mul_f32 v[158:159], v[76:77], v[76:77]
    v_rcp_f32 v20, v20
    v_pk_mul_f32 v[26:27], v[78:79], v[78:79]
    v_rcp_f32 v21, v21
    ds_read_b64_tr_b16 a[92:93], v147 offset:6144
    ds_read_b64_tr_b16 a[94:95], v147 offset:7168
    v_pk_fma_f32 v[154:155], v[154:155], v[30:31], s[4:5]
    v_pk_fma_f32 v[156:157], v[156:157], v[30:31], s[4:5]
    v_rcp_f32 v22, v22
    v_pk_fma_f32 v[158:159], v[158:159], v[30:31], s[4:5]
    v_rcp_f32 v23, v23
    s_add_u32 m0, s77, 0
    s_add_u32 s78, s76, 32768
    buffer_load_dwordx4 v0, s[44:47], s78 offen offset:0 lds
    v_pk_fma_f32 v[26:27], v[26:27], v[30:31], s[4:5]
    v_pk_mul_f32 v[154:155], v[154:155], v[72:73]
    v_rcp_f32 v24, v24
    v_pk_mul_f32 v[156:157], v[156:157], v[74:75]
    v_rcp_f32 v25, v25
    buffer_load_dwordx4 v148, s[44:47], s78 offen offset:1024 lds
    v_pk_mul_f32 v[158:159], v[158:159], v[76:77]
    v_pk_mul_f32 v[26:27], v[26:27], v[78:79]
    v_exp_f32 v154, v154
    v_pk_mul_f32 v[64:65], v[64:65], v[18:19]
    v_pk_mul_f32 v[66:67], v[66:67], v[20:21]
    v_exp_f32 v155, v155
    v_pk_mul_f32 v[68:69], v[68:69], v[22:23]
    v_pk_mul_f32 v[70:71], v[70:71], v[24:25]
    v_exp_f32 v156, v156
    v_cvt_pk_bf16_f32 v64, v64, v65
    v_cvt_pk_bf16_f32 v65, v66, v67
    v_exp_f32 v157, v157
    v_cvt_pk_bf16_f32 v66, v68, v69
    v_cvt_pk_bf16_f32 v67, v70, v71
    buffer_load_dwordx4 v149, s[44:47], s78 offen offset:2048 lds
    v_exp_f32 v158, v158
    buffer_store_dwordx4 v[64:67], v29, s[48:51], s72 offen offset:0 sc1
    v_pk_fma_f32 v[10:11], v[32:33], v[8:9], v[128:129]
    v_exp_f32 v159, v159
    v_pk_fma_f32 v[12:13], v[34:35], v[8:9], v[130:131]
    v_pk_fma_f32 v[14:15], v[36:37], v[8:9], v[132:133]
    v_exp_f32 v26, v26
    v_pk_fma_f32 v[16:17], v[38:39], v[8:9], v[134:135]
    v_pk_fma_f32 v[80:81], v[80:81], v[6:7], v[10:11]
    v_exp_f32 v27, v27
    v_pk_fma_f32 v[82:83], v[82:83], v[6:7], v[12:13]
    v_pk_fma_f32 v[84:85], v[84:85], v[6:7], v[14:15]
    v_pk_fma_f32 v[86:87], v[86:87], v[6:7], v[16:17]
    v_pk_add_f32 v[154:155], v[154:155], s[6:7]
    v_pk_add_f32 v[156:157], v[156:157], s[6:7]
    v_pk_add_f32 v[158:159], v[158:159], s[6:7]
    v_pk_add_f32 v[26:27], v[26:27], s[6:7]
    v_rcp_f32 v154, v154
    v_pk_mul_f32 v[10:11], v[80:81], v[80:81]
    v_rcp_f32 v155, v155
    v_pk_mul_f32 v[12:13], v[82:83], v[82:83]
    v_pk_mul_f32 v[14:15], v[84:85], v[84:85]
    v_rcp_f32 v156, v156
    v_pk_mul_f32 v[16:17], v[86:87], v[86:87]
    v_rcp_f32 v157, v157
    buffer_load_dwordx4 v150, s[44:47], s78 offen offset:3072 lds
    v_pk_fma_f32 v[10:11], v[10:11], v[30:31], s[4:5]
    v_pk_fma_f32 v[12:13], v[12:13], v[30:31], s[4:5]
    v_rcp_f32 v158, v158
    v_pk_fma_f32 v[14:15], v[14:15], v[30:31], s[4:5]
    v_rcp_f32 v159, v159
    v_pk_fma_f32 v[16:17], v[16:17], v[30:31], s[4:5]
    v_pk_mul_f32 v[10:11], v[10:11], v[80:81]
    v_rcp_f32 v26, v26
    v_pk_mul_f32 v[12:13], v[12:13], v[82:83]
    v_rcp_f32 v27, v27
    v_pk_mul_f32 v[14:15], v[14:15], v[84:85]
    v_pk_mul_f32 v[16:17], v[16:17], v[86:87]
    v_exp_f32 v10, v10
    v_pk_mul_f32 v[72:73], v[72:73], v[154:155]
    v_pk_mul_f32 v[74:75], v[74:75], v[156:157]
    v_exp_f32 v11, v11
    s_waitcnt vmcnt(9)
    ds_read_b64_tr_b16 v[96:97], v146 offset:32768
    ds_read_b64_tr_b16 v[98:99], v146 offset:33792
    v_pk_mul_f32 v[76:77], v[76:77], v[158:159]
    v_pk_mul_f32 v[78:79], v[78:79], v[26:27]
    v_exp_f32 v12, v12
    v_cvt_pk_bf16_f32 v72, v72, v73
    v_cvt_pk_bf16_f32 v73, v74, v75
    v_exp_f32 v13, v13
    v_cvt_pk_bf16_f32 v74, v76, v77
    v_cvt_pk_bf16_f32 v75, v78, v79
    ds_read_b64_tr_b16 v[100:101], v147 offset:32768
    ds_read_b64_tr_b16 v[102:103], v147 offset:33792
    v_exp_f32 v14, v14
    buffer_store_dwordx4 v[72:75], v29, s[48:51], s72 offen offset:1024 sc1
    v_pk_fma_f32 v[18:19], v[40:41], v[8:9], v[136:137]
    v_exp_f32 v15, v15
    v_pk_fma_f32 v[20:21], v[42:43], v[8:9], v[138:139]
    v_pk_fma_f32 v[22:23], v[44:45], v[8:9], v[140:141]
    v_exp_f32 v16, v16
    v_pk_fma_f32 v[24:25], v[46:47], v[8:9], v[142:143]
    ds_read_b64_tr_b16 v[104:105], v146 offset:34816
    ds_read_b64_tr_b16 v[106:107], v146 offset:35840
    v_pk_fma_f32 v[88:89], v[88:89], v[6:7], v[18:19]
    v_exp_f32 v17, v17
    v_pk_fma_f32 v[90:91], v[90:91], v[6:7], v[20:21]
    v_pk_fma_f32 v[92:93], v[92:93], v[6:7], v[22:23]
    v_pk_fma_f32 v[94:95], v[94:95], v[6:7], v[24:25]
    v_pk_add_f32 v[10:11], v[10:11], s[6:7]
    v_pk_add_f32 v[12:13], v[12:13], s[6:7]
    v_pk_add_f32 v[14:15], v[14:15], s[6:7]
    v_pk_add_f32 v[16:17], v[16:17], s[6:7]
    ds_read_b64_tr_b16 v[108:109], v147 offset:34816
    ds_read_b64_tr_b16 v[110:111], v147 offset:35840
    v_rcp_f32 v10, v10
    v_pk_mul_f32 v[18:19], v[88:89], v[88:89]
    v_rcp_f32 v11, v11
    v_pk_mul_f32 v[20:21], v[90:91], v[90:91]
    v_pk_mul_f32 v[22:23], v[92:93], v[92:93]
    v_rcp_f32 v12, v12
    v_pk_mul_f32 v[24:25], v[94:95], v[94:95]
    v_rcp_f32 v13, v13
    s_add_u32 s76, s76, 65536
    s_cmp_eq_u32 s76, s35
    s_cselect_b32 s76, s34, s76
    s_add_u32 m0, s77, 4096
    s_nop 0
    buffer_load_dwordx4 v0, s[44:47], s76 offen offset:0 lds
    v_pk_fma_f32 v[18:19], v[18:19], v[30:31], s[4:5]
    v_pk_fma_f32 v[20:21], v[20:21], v[30:31], s[4:5]
    v_rcp_f32 v14, v14
    v_pk_fma_f32 v[22:23], v[22:23], v[30:31], s[4:5]
    v_rcp_f32 v15, v15
    v_pk_fma_f32 v[24:25], v[24:25], v[30:31], s[4:5]
    v_pk_mul_f32 v[18:19], v[18:19], v[88:89]
    v_rcp_f32 v16, v16
    buffer_load_dwordx4 v148, s[44:47], s76 offen offset:1024 lds
    v_pk_mul_f32 v[20:21], v[20:21], v[90:91]
    v_rcp_f32 v17, v17
    v_pk_mul_f32 v[22:23], v[22:23], v[92:93]
    v_pk_mul_f32 v[24:25], v[24:25], v[94:95]
    v_exp_f32 v18, v18
    v_pk_mul_f32 v[80:81], v[80:81], v[10:11]
    v_exp_f32 v19, v19
    v_pk_mul_f32 v[82:83], v[82:83], v[12:13]
    v_exp_f32 v20, v20
    v_pk_mul_f32 v[84:85], v[84:85], v[14:15]
    v_exp_f32 v21, v21
    buffer_load_dwordx4 v149, s[44:47], s76 offen offset:2048 lds
    v_pk_mul_f32 v[86:87], v[86:87], v[16:17]
    v_exp_f32 v22, v22
    v_cvt_pk_bf16_f32 v80, v80, v81
    v_exp_f32 v23, v23
    v_cvt_pk_bf16_f32 v81, v82, v83
    v_exp_f32 v24, v24
    v_cvt_pk_bf16_f32 v82, v84, v85
    v_exp_f32 v25, v25
    v_cvt_pk_bf16_f32 v83, v86, v87
    buffer_store_dwordx4 v[80:83], v29, s[48:51], s73 offen offset:0 sc1
    v_pk_add_f32 v[18:19], v[18:19], s[6:7]
    v_pk_add_f32 v[20:21], v[20:21], s[6:7]
    v_pk_add_f32 v[22:23], v[22:23], s[6:7]
    v_pk_add_f32 v[24:25], v[24:25], s[6:7]
    v_rcp_f32 v18, v18
    buffer_load_dwordx4 v150, s[44:47], s76 offen offset:3072 lds
    v_rcp_f32 v19, v19
    v_rcp_f32 v20, v20
    v_rcp_f32 v21, v21
    v_rcp_f32 v22, v22
    v_rcp_f32 v23, v23
    v_rcp_f32 v24, v24
    v_rcp_f32 v25, v25
    v_pk_mul_f32 v[88:89], v[88:89], v[18:19]
    v_pk_mul_f32 v[90:91], v[90:91], v[20:21]
    v_pk_mul_f32 v[92:93], v[92:93], v[22:23]
    v_pk_mul_f32 v[94:95], v[94:95], v[24:25]
    v_cvt_pk_bf16_f32 v88, v88, v89
    v_cvt_pk_bf16_f32 v89, v90, v91
    v_cvt_pk_bf16_f32 v90, v92, v93
    v_cvt_pk_bf16_f32 v91, v94, v95
    buffer_store_dwordx4 v[88:91], v29, s[48:51], s73 offen offset:1024 sc1
    ds_write_b32 v153, v30 offset:80
    v_mov_b32 v10, s79
    v_mov_b32 v11, s60
    s_mov_b64 exec, 1
    s_waitcnt vmcnt(0)
    buffer_store_dword v11, v10, s[48:51], 0 offen sc1
    s_mov_b64 exec, -1
    s_waitcnt lgkmcnt(9)
    s_waitcnt lgkmcnt(1)
    s_add_u32 m0, s77, 32768
    s_add_u32 s78, s76, 32768
    buffer_load_dwordx4 v0, s[44:47], s78 offen offset:0 lds
    buffer_load_dwordx4 v148, s[44:47], s78 offen offset:1024 lds
    buffer_load_dwordx4 v149, s[44:47], s78 offen offset:2048 lds
    buffer_load_dwordx4 v150, s[44:47], s78 offen offset:3072 lds
    s_add_u32 s76, s76, 65536
    s_cmp_eq_u32 s76, s35
    s_cselect_b32 s76, s34, s76
    s_add_u32 m0, s77, 36864
    s_nop 0
    buffer_load_dwordx4 v0, s[44:47], s76 offen offset:0 lds
    buffer_load_dwordx4 v148, s[44:47], s76 offen offset:1024 lds
    buffer_load_dwordx4 v149, s[44:47], s76 offen offset:2048 lds
    buffer_load_dwordx4 v150, s[44:47], s76 offen offset:3072 lds
    s_add_u32 m0, s77, 65536
    s_add_u32 s78, s76, 32768
    buffer_load_dwordx4 v0, s[44:47], s78 offen offset:0 lds
    buffer_load_dwordx4 v148, s[44:47], s78 offen offset:1024 lds
    buffer_load_dwordx4 v149, s[44:47], s78 offen offset:2048 lds
    buffer_load_dwordx4 v150, s[44:47], s78 offen offset:3072 lds
    s_add_u32 s76, s76, 65536
    s_cmp_eq_u32 s76, s35
    s_cselect_b32 s76, s34, s76
    s_add_u32 m0, s77, 69632
    s_nop 0
    buffer_load_dwordx4 v0, s[44:47], s76 offen offset:0 lds
    buffer_load_dwordx4 v148, s[44:47], s76 offen offset:1024 lds
    buffer_load_dwordx4 v149, s[44:47], s76 offen offset:2048 lds
    buffer_load_dwordx4 v150, s[44:47], s76 offen offset:3072 lds
    s_add_u32 m0, s77, 98304
    s_add_u32 s78, s76, 32768
    buffer_load_dwordx4 v0, s[44:47], s78 offen offset:0 lds
    buffer_load_dwordx4 v148, s[44:47], s78 offen offset:1024 lds
    buffer_load_dwordx4 v149, s[44:47], s78 offen offset:2048 lds
    buffer_load_dwordx4 v150, s[44:47], s78 offen offset:3072 lds
Lg2:
    s_mov_b32 s52, s28
    s_mov_b32 s53, s29
    s_mov_b32 s54, 0x200000
    s_mov_b32 s55, 0x00020000
    s_mul_i32 s63, s3, 28
    s_mul_i32 s62, s57, 7
    s_add_u32 s63, s63, s62
    s_lshl_b32 s63, s63, 7
    s_add_u32 s63, s63, 0x20000
    v_min_u32 v2, 6, v1
    v_lshlrev_b32 v2, 7, v2
    v_add_u32 v2, s63, v2
    buffer_load_dword v3, v2, s[48:51], 0 offen sc1
    s_mul_i32 s18, s3, 224
    s_mul_i32 s62, s57, 28
    s_add_u32 s18, s18, s62
    s_lshl_b32 s18, s18, 10
    s_add_u32 s18, s18, 0x500000
    s_add_u32 s19, s18, 28672
    s_lshl_b32 s73, s100, 12
    s_add_u32 s73, s73, s18
    s_lshl_b32 s8, s3, 6
    s_lshr_b32 s10, s57, 1
    s_lshl_b32 s10, s10, 5
    s_add_u32 s8, s8, s10
    s_lshl_b32 s9, s69, 6
    s_and_b32 s10, s57, 1
    s_lshl_b32 s10, s10, 5
    s_add_u32 s9, s9, s10
    v_lshrrev_b32 v4, 5, v1
    s_and_b32 s10, s57, 1
    s_lshl_b32 s10, s10, 6
    s_add_u32 s10, s10, 159616
    v_lshl_add_u32 v4, v4, 3, s10
    ds_read_b64 v[120:121], v4 offset:0
    ds_read_b64 v[122:123], v4 offset:16
    ds_read_b64 v[124:125], v4 offset:32
    ds_read_b64 v[126:127], v4 offset:48
    s_waitcnt lgkmcnt(3)
    v_lshlrev_b32 v32, 16, v120
    v_and_b32 v33, 0xffff0000, v120
    v_lshlrev_b32 v34, 16, v121
    v_and_b32 v35, 0xffff0000, v121
    s_waitcnt lgkmcnt(2)
    v_lshlrev_b32 v36, 16, v122
    v_and_b32 v37, 0xffff0000, v122
    v_lshlrev_b32 v38, 16, v123
    v_and_b32 v39, 0xffff0000, v123
    s_waitcnt lgkmcnt(1)
    v_lshlrev_b32 v40, 16, v124
    v_and_b32 v41, 0xffff0000, v124
    v_lshlrev_b32 v42, 16, v125
    v_and_b32 v43, 0xffff0000, v125
    s_waitcnt lgkmcnt(0)
    v_lshlrev_b32 v44, 16, v126
    v_and_b32 v45, 0xffff0000, v126
    v_lshlrev_b32 v46, 16, v127
    v_and_b32 v47, 0xffff0000, v127
    s_waitcnt vmcnt(0)
    v_cmp_ne_u32 vcc, s60, v3
    s_nop 0
    s_cbranch_vccnz Lgs52
Lgk53:
    buffer_load_dwordx4 v[128:131], v152, s[48:51], s73 offen offset:0 sc1
    buffer_load_dwordx4 v[132:135], v151, s[48:51], s73 offen offset:0 sc1
    buffer_load_dwordx4 v[136:139], v152, s[48:51], s73 offen offset:1024 sc1
    buffer_load_dwordx4 v[140:143], v151, s[48:51], s73 offen offset:1024 sc1
    buffer_load_dwordx4 v[4:7], v152, s[48:51], s73 offen offset:2048 sc1
    buffer_load_dwordx4 v[8:11], v151, s[48:51], s73 offen offset:2048 sc1
    buffer_load_dwordx4 v[12:15], v152, s[48:51], s73 offen offset:3072 sc1
    buffer_load_dwordx4 v[16:19], v151, s[48:51], s73 offen offset:3072 sc1
    s_add_u32 s73, s73, 4096
    s_cmp_eq_u32 s73, s19
    s_cselect_b32 s73, s18, s73
    buffer_load_dwordx4 v[20:23], v152, s[48:51], s73 offen offset:0 sc1
    buffer_load_dwordx4 v[24:27], v151, s[48:51], s73 offen offset:0 sc1
    buffer_load_dwordx4 v[28:31], v152, s[48:51], s73 offen offset:1024 sc1
    buffer_load_dwordx4 v[156:159], v151, s[48:51], s73 offen offset:1024 sc1
    buffer_load_dwordx4 v[112:115], v152, s[48:51], s73 offen offset:2048 sc1
    buffer_load_dwordx4 v[116:119], v151, s[48:51], s73 offen offset:2048 sc1
    buffer_load_dwordx4 v[120:123], v152, s[48:51], s73 offen offset:3072 sc1
    buffer_load_dwordx4 v[124:127], v151, s[48:51], s73 offen offset:3072 sc1
    s_waitcnt vmcnt(15)
    v_mfma_f32_32x32x16_bf16 v[32:47], a[0:3], v[128:131], v[32:47]
    s_waitcnt vmcnt(14)
    v_mfma_f32_32x32x16_bf16 v[48:63], a[0:3], v[132:135], 0
    v_mfma_f32_32x32x16_bf16 v[64:79], a[4:7], v[128:131], 0
    v_mfma_f32_32x32x16_bf16 v[80:95], a[4:7], v[132:135], 0
    s_add_u32 s73, s73, 4096
    s_cmp_eq_u32 s73, s19
    s_cselect_b32 s73, s18, s73
    buffer_load_dwordx4 v[128:131], v152, s[48:51], s73 offen offset:0 sc1
    buffer_load_dwordx4 v[132:135], v151, s[48:51], s73 offen offset:0 sc1
    ds_read_b64_tr_b16 a[0:1], v144 offset:0
    ds_read_b64_tr_b16 a[2:3], v144 offset:1024
    ds_read_b64_tr_b16 a[4:5], v145 offset:0
    ds_read_b64_tr_b16 a[6:7], v145 offset:1024
    s_waitcnt vmcnt(15)
    v_mfma_f32_32x32x16_bf16 v[32:47], a[8:11], v[136:139], v[32:47]
    s_waitcnt vmcnt(14)
    v_mfma_f32_32x32x16_bf16 v[48:63], a[8:11], v[140:143], v[48:63]
    v_mfma_f32_32x32x16_bf16 v[64:79], a[12:15], v[136:139], v[64:79]
    v_mfma_f32_32x32x16_bf16 v[80:95], a[12:15], v[140:143], v[80:95]
    buffer_load_dwordx4 v[136:139], v152, s[48:51], s73 offen offset:1024 sc1
    buffer_load_dwordx4 v[140:143], v151, s[48:51], s73 offen offset:1024 sc1
    ds_read_b64_tr_b16 a[8:9], v144 offset:2048
    ds_read_b64_tr_b16 a[10:11], v144 offset:3072
    ds_read_b64_tr_b16 a[12:13], v145 offset:2048
    ds_read_b64_tr_b16 a[14:15], v145 offset:3072
    s_waitcnt vmcnt(15)
    v_mfma_f32_32x32x16_bf16 v[32:47], a[16:19], v[4:7], v[32:47]
    s_waitcnt vmcnt(14)
    v_mfma_f32_32x32x16_bf16 v[48:63], a[16:19], v[8:11], v[48:63]
    v_mfma_f32_32x32x16_bf16 v[64:79], a[20:23], v[4:7], v[64:79]
    v_mfma_f32_32x32x16_bf16 v[80:95], a[20:23], v[8:11], v[80:95]
    buffer_load_dwordx4 v[4:7], v152, s[48:51], s73 offen offset:2048 sc1
    buffer_load_dwordx4 v[8:11], v151, s[48:51], s73 offen offset:2048 sc1
    ds_read_b64_tr_b16 a[16:17], v144 offset:4096
    ds_read_b64_tr_b16 a[18:19], v144 offset:5120
    ds_read_b64_tr_b16 a[20:21], v145 offset:4096
    ds_read_b64_tr_b16 a[22:23], v145 offset:5120
    s_waitcnt vmcnt(15)
    v_mfma_f32_32x32x16_bf16 v[32:47], a[24:27], v[12:15], v[32:47]
    s_waitcnt vmcnt(14)
    v_mfma_f32_32x32x16_bf16 v[48:63], a[24:27], v[16:19], v[48:63]
    v_mfma_f32_32x32x16_bf16 v[64:79], a[28:31], v[12:15], v[64:79]
    v_mfma_f32_32x32x16_bf16 v[80:95], a[28:31], v[16:19], v[80:95]
    buffer_load_dwordx4 v[12:15], v152, s[48:51], s73 offen offset:3072 sc1
    buffer_load_dwordx4 v[16:19], v151, s[48:51], s73 offen offset:3072 sc1
    ds_read_b64_tr_b16 a[24:25], v144 offset:6144
    ds_read_b64_tr_b16 a[26:27], v144 offset:7168
    ds_read_b64_tr_b16 a[28:29], v145 offset:6144
    ds_read_b64_tr_b16 a[30:31], v145 offset:7168
    s_waitcnt vmcnt(15)
    v_mfma_f32_32x32x16_bf16 v[32:47], a[32:35], v[20:23], v[32:47]
    s_waitcnt vmcnt(14)
    v_mfma_f32_32x32x16_bf16 v[48:63], a[32:35], v[24:27], v[48:63]
    v_mfma_f32_32x32x16_bf16 v[64:79], a[36:39], v[20:23], v[64:79]
    v_mfma_f32_32x32x16_bf16 v[80:95], a[36:39], v[24:27], v[80:95]
    s_add_u32 s73, s73, 4096
    s_cmp_eq_u32 s73, s19
    s_cselect_b32 s73, s18, s73
    buffer_load_dwordx4 v[20:23], v152, s[48:51], s73 offen offset:0 sc1
    buffer_load_dwordx4 v[24:27], v151, s[48:51], s73 offen offset:0 sc1
    ds_read_b64_tr_b16 a[32:33], v144 offset:32768
    ds_read_b64_tr_b16 a[34:35], v144 offset:33792
    ds_read_b64_tr_b16 a[36:37], v145 offset:32768
    ds_read_b64_tr_b16 a[38:39], v145 offset:33792
    s_waitcnt vmcnt(15)
    v_mfma_f32_32x32x16_bf16 v[32:47], a[40:43], v[28:31], v[32:47]
    s_waitcnt vmcnt(14)
    v_mfma_f32_32x32x16_bf16 v[48:63], a[40:43], v[156:159], v[48:63]
    v_mfma_f32_32x32x16_bf16 v[64:79], a[44:47], v[28:31], v[64:79]
    v_mfma_f32_32x32x16_bf16 v[80:95], a[44:47], v[156:159], v[80:95]
    buffer_load_dwordx4 v[28:31], v152, s[48:51], s73 offen offset:1024 sc1
    buffer_load_dwordx4 v[156:159], v151, s[48:51], s73 offen offset:1024 sc1
    ds_read_b64_tr_b16 a[40:41], v144 offset:34816
    ds_read_b64_tr_b16 a[42:43], v144 offset:35840
    ds_read_b64_tr_b16 a[44:45], v145 offset:34816
    ds_read_b64_tr_b16 a[46:47], v145 offset:35840
    s_waitcnt vmcnt(15)
    v_mfma_f32_32x32x16_bf16 v[32:47], a[48:51], v[112:115], v[32:47]
    s_waitcnt vmcnt(14)
    v_mfma_f32_32x32x16_bf16 v[48:63], a[48:51], v[116:119], v[48:63]
    v_mfma_f32_32x32x16_bf16 v[64:79], a[52:55], v[112:115], v[64:79]
    v_mfma_f32_32x32x16_bf16 v[80:95], a[52:55], v[116:119], v[80:95]
    buffer_load_dwordx4 v[112:115], v152, s[48:51], s73 offen offset:2048 sc1
    buffer_load_dwordx4 v[116:119], v151, s[48:51], s73 offen offset:2048 sc1
    ds_read_b64_tr_b16 a[48:49], v144 offset:36864
    ds_read_b64_tr_b16 a[50:51], v144 offset:37888
    ds_read_b64_tr_b16 a[52:53], v145 offset:36864
    ds_read_b64_tr_b16 a[54:55], v145 offset:37888
    s_waitcnt vmcnt(15)
    v_mfma_f32_32x32x16_bf16 v[32:47], a[56:59], v[120:123], v[32:47]
    s_waitcnt vmcnt(14)
    v_mfma_f32_32x32x16_bf16 v[48:63], a[56:59], v[124:127], v[48:63]
    v_mfma_f32_32x32x16_bf16 v[64:79], a[60:63], v[120:123], v[64:79]
    v_mfma_f32_32x32x16_bf16 v[80:95], a[60:63], v[124:127], v[80:95]
    buffer_load_dwordx4 v[120:123], v152, s[48:51], s73 offen offset:3072 sc1
    buffer_load_dwordx4 v[124:127], v151, s[48:51], s73 offen offset:3072 sc1
    ds_read_b64_tr_b16 a[56:57], v144 offset:38912
    ds_read_b64_tr_b16 a[58:59], v144 offset:39936
    ds_read_b64_tr_b16 a[60:61], v145 offset:38912
    ds_read_b64_tr_b16 a[62:63], v145 offset:39936
    s_waitcnt vmcnt(15)
    v_mfma_f32_32x32x16_bf16 v[32:47], a[64:67], v[128:131], v[32:47]
    s_waitcnt vmcnt(14)
    v_mfma_f32_32x32x16_bf16 v[48:63], a[64:67], v[132:135], v[48:63]
    v_mfma_f32_32x32x16_bf16 v[64:79], a[68:71], v[128:131], v[64:79]
    v_mfma_f32_32x32x16_bf16 v[80:95], a[68:71], v[132:135], v[80:95]
    s_add_u32 s73, s73, 4096
    s_cmp_eq_u32 s73, s19
    s_cselect_b32 s73, s18, s73
    buffer_load_dwordx4 v[128:131], v152, s[48:51], s73 offen offset:0 sc1
    buffer_load_dwordx4 v[132:135], v151, s[48:51], s73 offen offset:0 sc1
    ds_read_b64_tr_b16 a[64:65], v146 offset:0
    ds_read_b64_tr_b16 a[66:67], v146 offset:1024
    ds_read_b64_tr_b16 a[68:69], v147 offset:0
    ds_read_b64_tr_b16 a[70:71], v147 offset:1024
    s_waitcnt vmcnt(15)
    v_mfma_f32_32x32x16_bf16 v[32:47], a[72:75], v[136:139], v[32:47]
    s_waitcnt vmcnt(14)
    v_mfma_f32_32x32x16_bf16 v[48:63], a[72:75], v[140:143], v[48:63]
    v_mfma_f32_32x32x16_bf16 v[64:79], a[76:79], v[136:139], v[64:79]
    v_mfma_f32_32x32x16_bf16 v[80:95], a[76:79], v[140:143], v[80:95]
    buffer_load_dwordx4 v[136:139], v152, s[48:51], s73 offen offset:1024 sc1
    buffer_load_dwordx4 v[140:143], v151, s[48:51], s73 offen offset:1024 sc1
    ds_read_b64_tr_b16 a[72:73], v146 offset:2048
    ds_read_b64_tr_b16 a[74:75], v146 offset:3072
    ds_read_b64_tr_b16 a[76:77], v147 offset:2048
    ds_read_b64_tr_b16 a[78:79], v147 offset:3072
    s_waitcnt vmcnt(15)
    v_mfma_f32_32x32x16_bf16 v[32:47], a[80:83], v[4:7], v[32:47]
    s_waitcnt vmcnt(14)
    v_mfma_f32_32x32x16_bf16 v[48:63], a[80:83], v[8:11], v[48:63]
    v_mfma_f32_32x32x16_bf16 v[64:79], a[84:87], v[4:7], v[64:79]
    v_mfma_f32_32x32x16_bf16 v[80:95], a[84:87], v[8:11], v[80:95]
    buffer_load_dwordx4 v[4:7], v152, s[48:51], s73 offen offset:2048 sc1
    buffer_load_dwordx4 v[8:11], v151, s[48:51], s73 offen offset:2048 sc1
    ds_read_b64_tr_b16 a[80:81], v146 offset:4096
    ds_read_b64_tr_b16 a[82:83], v146 offset:5120
    ds_read_b64_tr_b16 a[84:85], v147 offset:4096
    ds_read_b64_tr_b16 a[86:87], v147 offset:5120
    s_waitcnt vmcnt(15)
    v_mfma_f32_32x32x16_bf16 v[32:47], a[88:91], v[12:15], v[32:47]
    s_waitcnt vmcnt(14)
    v_mfma_f32_32x32x16_bf16 v[48:63], a[88:91], v[16:19], v[48:63]
    v_mfma_f32_32x32x16_bf16 v[64:79], a[92:95], v[12:15], v[64:79]
    v_mfma_f32_32x32x16_bf16 v[80:95], a[92:95], v[16:19], v[80:95]
    buffer_load_dwordx4 v[12:15], v152, s[48:51], s73 offen offset:3072 sc1
    buffer_load_dwordx4 v[16:19], v151, s[48:51], s73 offen offset:3072 sc1
    ds_read_b64_tr_b16 a[88:89], v146 offset:6144
    ds_read_b64_tr_b16 a[90:91], v146 offset:7168
    ds_read_b64_tr_b16 a[92:93], v147 offset:6144
    ds_read_b64_tr_b16 a[94:95], v147 offset:7168
    s_waitcnt vmcnt(15)
    v_mfma_f32_32x32x16_bf16 v[32:47], v[96:99], v[20:23], v[32:47]
    s_waitcnt vmcnt(14)
    v_mfma_f32_32x32x16_bf16 v[48:63], v[96:99], v[24:27], v[48:63]
    v_mfma_f32_32x32x16_bf16 v[64:79], v[100:103], v[20:23], v[64:79]
    v_mfma_f32_32x32x16_bf16 v[80:95], v[100:103], v[24:27], v[80:95]
    s_add_u32 s73, s73, 4096
    s_cmp_eq_u32 s73, s19
    s_cselect_b32 s73, s18, s73
    buffer_load_dwordx4 v[20:23], v152, s[48:51], s73 offen offset:0 sc1
    buffer_load_dwordx4 v[24:27], v151, s[48:51], s73 offen offset:0 sc1
    s_waitcnt vmcnt(15)
    v_mfma_f32_32x32x16_bf16 v[32:47], v[104:107], v[28:31], v[32:47]
    s_waitcnt vmcnt(14)
    v_mfma_f32_32x32x16_bf16 v[48:63], v[104:107], v[156:159], v[48:63]
    v_mfma_f32_32x32x16_bf16 v[64:79], v[108:111], v[28:31], v[64:79]
    v_mfma_f32_32x32x16_bf16 v[80:95], v[108:111], v[156:159], v[80:95]
    buffer_load_dwordx4 v[28:31], v152, s[48:51], s73 offen offset:1024 sc1
    buffer_load_dwordx4 v[156:159], v151, s[48:51], s73 offen offset:1024 sc1
    s_waitcnt vmcnt(15) lgkmcnt(15)
    v_mfma_f32_32x32x16_bf16 v[32:47], a[0:3], v[112:115], v[32:47]
    s_waitcnt vmcnt(14)
    v_mfma_f32_32x32x16_bf16 v[48:63], a[0:3], v[116:119], v[48:63]
    v_mfma_f32_32x32x16_bf16 v[64:79], a[4:7], v[112:115], v[64:79]
    v_mfma_f32_32x32x16_bf16 v[80:95], a[4:7], v[116:119], v[80:95]
    buffer_load_dwordx4 v[112:115], v152, s[48:51], s73 offen offset:2048 sc1
    buffer_load_dwordx4 v[116:119], v151, s[48:51], s73 offen offset:2048 sc1
    ds_read_b64_tr_b16 a[0:1], v146 offset:32768
    ds_read_b64_tr_b16 a[2:3], v146 offset:33792
    ds_read_b64_tr_b16 a[4:5], v147 offset:32768
    ds_read_b64_tr_b16 a[6:7], v147 offset:33792
    s_waitcnt vmcnt(15)
    v_mfma_f32_32x32x16_bf16 v[32:47], a[8:11], v[120:123], v[32:47]
    s_waitcnt vmcnt(14)
    v_mfma_f32_32x32x16_bf16 v[48:63], a[8:11], v[124:127], v[48:63]
    v_mfma_f32_32x32x16_bf16 v[64:79], a[12:15], v[120:123], v[64:79]
    v_mfma_f32_32x32x16_bf16 v[80:95], a[12:15], v[124:127], v[80:95]
    buffer_load_dwordx4 v[120:123], v152, s[48:51], s73 offen offset:3072 sc1
    buffer_load_dwordx4 v[124:127], v151, s[48:51], s73 offen offset:3072 sc1
    ds_read_b64_tr_b16 a[8:9], v146 offset:34816
    ds_read_b64_tr_b16 a[10:11], v146 offset:35840
    ds_read_b64_tr_b16 a[12:13], v147 offset:34816
    ds_read_b64_tr_b16 a[14:15], v147 offset:35840
    s_waitcnt vmcnt(15)
    v_mfma_f32_32x32x16_bf16 v[32:47], a[16:19], v[128:131], v[32:47]
    s_waitcnt vmcnt(14)
    v_mfma_f32_32x32x16_bf16 v[48:63], a[16:19], v[132:135], v[48:63]
    v_mfma_f32_32x32x16_bf16 v[64:79], a[20:23], v[128:131], v[64:79]
    v_mfma_f32_32x32x16_bf16 v[80:95], a[20:23], v[132:135], v[80:95]
    s_add_u32 s73, s73, 4096
    s_cmp_eq_u32 s73, s19
    s_cselect_b32 s73, s18, s73
    buffer_load_dwordx4 v[128:131], v152, s[48:51], s73 offen offset:0 sc1
    buffer_load_dwordx4 v[132:135], v151, s[48:51], s73 offen offset:0 sc1
    s_waitcnt vmcnt(15)
    v_mfma_f32_32x32x16_bf16 v[32:47], a[24:27], v[136:139], v[32:47]
    s_waitcnt vmcnt(14)
    v_mfma_f32_32x32x16_bf16 v[48:63], a[24:27], v[140:143], v[48:63]
    v_mfma_f32_32x32x16_bf16 v[64:79], a[28:31], v[136:139], v[64:79]
    v_mfma_f32_32x32x16_bf16 v[80:95], a[28:31], v[140:143], v[80:95]
    buffer_load_dwordx4 v[136:139], v152, s[48:51], s73 offen offset:1024 sc1
    buffer_load_dwordx4 v[140:143], v151, s[48:51], s73 offen offset:1024 sc1
    s_waitcnt vmcnt(15)
    v_mfma_f32_32x32x16_bf16 v[32:47], a[32:35], v[4:7], v[32:47]
    s_waitcnt vmcnt(14)
    v_mfma_f32_32x32x16_bf16 v[48:63], a[32:35], v[8:11], v[48:63]
    v_mfma_f32_32x32x16_bf16 v[64:79], a[36:39], v[4:7], v[64:79]
    v_mfma_f32_32x32x16_bf16 v[80:95], a[36:39], v[8:11], v[80:95]
    buffer_load_dwordx4 v[4:7], v152, s[48:51], s73 offen offset:2048 sc1
    buffer_load_dwordx4 v[8:11], v151, s[48:51], s73 offen offset:2048 sc1
    s_waitcnt vmcnt(15)
    v_mfma_f32_32x32x16_bf16 v[32:47], a[40:43], v[12:15], v[32:47]
    s_waitcnt vmcnt(14)
    v_mfma_f32_32x32x16_bf16 v[48:63], a[40:43], v[16:19], v[48:63]
    v_mfma_f32_32x32x16_bf16 v[64:79], a[44:47], v[12:15], v[64:79]
    v_mfma_f32_32x32x16_bf16 v[80:95], a[44:47], v[16:19], v[80:95]
    buffer_load_dwordx4 v[12:15], v152, s[48:51], s73 offen offset:3072 sc1
    buffer_load_dwordx4 v[16:19], v151, s[48:51], s73 offen offset:3072 sc1
    s_waitcnt vmcnt(15)
    v_mfma_f32_32x32x16_bf16 v[32:47], a[48:51], v[20:23], v[32:47]
    s_waitcnt vmcnt(14)
    v_mfma_f32_32x32x16_bf16 v[48:63], a[48:51], v[24:27], v[48:63]
    v_mfma_f32_32x32x16_bf16 v[64:79], a[52:55], v[20:23], v[64:79]
    v_mfma_f32_32x32x16_bf16 v[80:95], a[52:55], v[24:27], v[80:95]
    s_lshr_b32 s61, s9, 5
    s_lshl_b32 s61, s61, 1
    s_lshr_b32 s62, s3, 4
    s_add_u32 s61, s61, s62
    s_lshl_b32 s61, s61, 7
    s_add_u32 s61, s61, 0x48000
    v_and_b32 v2, 31, v1
    v_lshlrev_b32 v3, 2, v2
    v_add_u32 v3, s61, v3
    buffer_load_dword v153, v3, s[48:51], 0 offen sc1
    v_add_u32 v2, s8, v2
    v_lshrrev_b32 v154, 5, v1
    v_lshlrev_b32 v155, 2, v154
    v_add_u32 v155, s9, v155
    v_lshlrev_b32 v150, 1, v155
    v_lshl_add_u32 v149, v2, 10, v150
    v_mov_b32 v96, 0
    v_mov_b32 v97, 0
    v_mov_b32 v98, 0
    v_mov_b32 v99, 0
    v_mov_b32 v100, 0
    v_mov_b32 v101, 0
    v_mov_b32 v102, 0
    v_mov_b32 v103, 0
    v_mov_b32 v104, 0
    v_mov_b32 v105, 0
    v_mov_b32 v106, 0
    v_mov_b32 v107, 0
    v_mov_b32 v108, 0
    v_mov_b32 v109, 0
    v_mov_b32 v110, 0
    v_mov_b32 v111, 0
    v_lshlrev_b32 v150, 4, v1
    s_lshl_b32 s61, s57, 13
    v_add_u32 v150, s61, v150
    v_add_u32 v148, 0x10000, v150
    v_xor_b32 v144, 8192, v150
    v_xor_b32 v145, 16384, v150
    v_xor_b32 v146, 24576, v148
    v_lshlrev_b32 v155, 12, v155
    v_lshl_add_u32 v155, v2, 1, v155
    v_lshl_add_u32 v149, v154, 3, v149
    buffer_load_dwordx4 v[20:23], v149, s[36:39], 0 offen offset:0
    buffer_load_dwordx4 v[24:27], v149, s[36:39], 0 offen offset:32
    s_waitcnt vmcnt(16)
    v_mfma_f32_32x32x16_bf16 v[32:47], a[56:59], v[28:31], v[32:47]
    s_waitcnt vmcnt(15)
    v_mfma_f32_32x32x16_bf16 v[48:63], a[56:59], v[156:159], v[48:63]
    v_mfma_f32_32x32x16_bf16 v[64:79], a[60:63], v[28:31], v[64:79]
    v_mfma_f32_32x32x16_bf16 v[80:95], a[60:63], v[156:159], v[80:95]
    s_waitcnt vmcnt(14) lgkmcnt(15)
    v_mfma_f32_32x32x16_bf16 v[32:47], a[64:67], v[112:115], v[32:47]
    s_waitcnt vmcnt(13)
    v_mfma_f32_32x32x16_bf16 v[48:63], a[64:67], v[116:119], v[48:63]
    v_mfma_f32_32x32x16_bf16 v[64:79], a[68:71], v[112:115], v[64:79]
    v_mfma_f32_32x32x16_bf16 v[80:95], a[68:71], v[116:119], v[80:95]
    s_waitcnt vmcnt(12)
    v_mfma_f32_32x32x16_bf16 v[32:47], a[72:75], v[120:123], v[32:47]
    s_waitcnt vmcnt(11)
    v_mfma_f32_32x32x16_bf16 v[48:63], a[72:75], v[124:127], v[48:63]
    v_mfma_f32_32x32x16_bf16 v[64:79], a[76:79], v[120:123], v[64:79]
    v_mfma_f32_32x32x16_bf16 v[80:95], a[76:79], v[124:127], v[80:95]
    s_waitcnt vmcnt(10) lgkmcnt(14)
    v_mfma_f32_32x32x16_bf16 v[32:47], a[80:83], v[128:131], v[32:47]
    s_waitcnt vmcnt(9)
    v_mfma_f32_32x32x16_bf16 v[48:63], a[80:83], v[132:135], v[48:63]
    s_waitcnt lgkmcnt(12)
    v_mfma_f32_32x32x16_bf16 v[64:79], a[84:87], v[128:131], v[64:79]
    v_mfma_f32_32x32x16_bf16 v[80:95], a[84:87], v[132:135], v[80:95]
    s_waitcnt vmcnt(8) lgkmcnt(10)
    v_mfma_f32_32x32x16_bf16 v[32:47], a[88:91], v[136:139], v[32:47]
    s_waitcnt vmcnt(7)
    v_mfma_f32_32x32x16_bf16 v[48:63], a[88:91], v[140:143], v[48:63]
    s_waitcnt lgkmcnt(8)
    v_mfma_f32_32x32x16_bf16 v[64:79], a[92:95], v[136:139], v[64:79]
    v_mfma_f32_32x32x16_bf16 v[80:95], a[92:95], v[140:143], v[80:95]
    s_waitcnt vmcnt(6) lgkmcnt(6)
    v_mfma_f32_32x32x16_bf16 v[32:47], a[0:3], v[4:7], v[32:47]
    s_waitcnt vmcnt(5)
    v_mfma_f32_32x32x16_bf16 v[48:63], a[0:3], v[8:11], v[48:63]
    s_waitcnt lgkmcnt(4)
    v_mfma_f32_32x32x16_bf16 v[64:79], a[4:7], v[4:7], v[64:79]
    v_mfma_f32_32x32x16_bf16 v[80:95], a[4:7], v[8:11], v[80:95]
    s_waitcnt vmcnt(1)
    v_permlane32_swap_b32 v20, v22
    v_permlane32_swap_b32 v21, v23
    s_waitcnt vmcnt(0)
    v_permlane32_swap_b32 v24, v26
    v_permlane32_swap_b32 v25, v27
    v_lshlrev_b32 v28, 16, v20
    v_and_b32 v29, 0xffff0000, v20
    v_lshlrev_b32 v30, 16, v21
    v_and_b32 v31, 0xffff0000, v21
    v_lshlrev_b32 v156, 16, v22
    v_and_b32 v157, 0xffff0000, v22
    v_lshlrev_b32 v158, 16, v23
    v_and_b32 v159, 0xffff0000, v23
    v_lshlrev_b32 v112, 16, v24
    v_and_b32 v113, 0xffff0000, v24
    v_lshlrev_b32 v114, 16, v25
    v_and_b32 v115, 0xffff0000, v25
    v_lshlrev_b32 v116, 16, v26
    v_and_b32 v117, 0xffff0000, v26
    v_lshlrev_b32 v118, 16, v27
    v_and_b32 v119, 0xffff0000, v27
    v_cmp_ne_u32 vcc, s60, v153
    s_nop 0
    s_cbranch_vccnz Lgs55
Lgk56:
    s_mov_b32 s61, 0x300000
    buffer_load_short_d16_hi v96, v155, s[48:51], s61 offen sc1
    s_mov_b32 s61, 0x301000
    buffer_load_short_d16_hi v97, v155, s[48:51], s61 offen sc1
    s_mov_b32 s61, 0x302000
    buffer_load_short_d16_hi v98, v155, s[48:51], s61 offen sc1
    s_mov_b32 s61, 0x303000
    buffer_load_short_d16_hi v99, v155, s[48:51], s61 offen sc1
    s_mov_b32 s61, 0x308000
    buffer_load_short_d16_hi v100, v155, s[48:51], s61 offen sc1
    s_mov_b32 s61, 0x309000
    buffer_load_short_d16_hi v101, v155, s[48:51], s61 offen sc1
    s_mov_b32 s61, 0x30a000
    buffer_load_short_d16_hi v102, v155, s[48:51], s61 offen sc1
    s_mov_b32 s61, 0x30b000
    buffer_load_short_d16_hi v103, v155, s[48:51], s61 offen sc1
    s_mov_b32 s61, 0x310000
    buffer_load_short_d16_hi v104, v155, s[48:51], s61 offen sc1
    s_mov_b32 s61, 0x311000
    buffer_load_short_d16_hi v105, v155, s[48:51], s61 offen sc1
    s_mov_b32 s61, 0x312000
    buffer_load_short_d16_hi v106, v155, s[48:51], s61 offen sc1
    s_mov_b32 s61, 0x313000
    buffer_load_short_d16_hi v107, v155, s[48:51], s61 offen sc1
    s_mov_b32 s61, 0x318000
    buffer_load_short_d16_hi v108, v155, s[48:51], s61 offen sc1
    s_mov_b32 s61, 0x319000
    buffer_load_short_d16_hi v109, v155, s[48:51], s61 offen sc1
    s_mov_b32 s61, 0x31a000
    buffer_load_short_d16_hi v110, v155, s[48:51], s61 offen sc1
    s_mov_b32 s61, 0x31b000
    buffer_load_short_d16_hi v111, v155, s[48:51], s61 offen sc1
    s_waitcnt lgkmcnt(0)
    v_mfma_f32_32x32x16_bf16 v[64:79], a[12:15], v[12:15], v[64:79]
    v_mfma_f32_32x32x16_bf16 v[48:63], a[8:11], v[16:19], v[48:63]
    v_mfma_f32_32x32x16_bf16 v[80:95], a[12:15], v[16:19], v[80:95]
    v_mfma_f32_32x32x16_bf16 v[32:47], a[8:11], v[12:15], v[32:47]
    s_nop 8
    ds_write_b128 v150, v[64:67] offset:0
    ds_write_b128 v150, v[68:71] offset:1024
    ds_write_b128 v150, v[72:75] offset:2048
    ds_write_b128 v150, v[76:79] offset:3072
    ds_write_b128 v150, v[48:51] offset:32768
    ds_write_b128 v150, v[52:55] offset:33792
    ds_write_b128 v150, v[56:59] offset:34816
    ds_write_b128 v150, v[60:63] offset:35840
    ds_write_b128 v148, v[80:83] offset:0
    ds_write_b128 v148, v[84:87] offset:1024
    ds_write_b128 v148, v[88:91] offset:2048
    ds_write_b128 v148, v[92:95] offset:3072
    v_pk_add_f32 v[32:33], v[32:33], v[28:29]
    v_pk_add_f32 v[34:35], v[34:35], v[30:31]
    v_pk_add_f32 v[36:37], v[36:37], v[156:157]
    v_pk_add_f32 v[38:39], v[38:39], v[158:159]
    v_pk_add_f32 v[40:41], v[40:41], v[112:113]
    v_pk_add_f32 v[42:43], v[42:43], v[114:115]
    v_pk_add_f32 v[44:45], v[44:45], v[116:117]
    v_pk_add_f32 v[46:47], v[46:47], v[118:119]
    s_waitcnt lgkmcnt(0)
    s_barrier
    ds_read_b128 v[64:67], v144 offset:0
    ds_read_b128 v[48:51], v145 offset:32768
    ds_read_b128 v[80:83], v146 offset:0
    ds_read_b128 v[68:71], v144 offset:1024
    ds_read_b128 v[52:55], v145 offset:33792
    ds_read_b128 v[84:87], v146 offset:1024
    ds_read_b128 v[72:75], v144 offset:2048
    ds_read_b128 v[56:59], v145 offset:34816
    ds_read_b128 v[88:91], v146 offset:2048
    ds_read_b128 v[76:79], v144 offset:3072
    ds_read_b128 v[60:63], v145 offset:35840
    ds_read_b128 v[92:95], v146 offset:3072
    s_waitcnt lgkmcnt(11)
    v_pk_add_f32 v[32:33], v[32:33], v[64:65]
    v_pk_add_f32 v[34:35], v[34:35], v[66:67]
    s_waitcnt lgkmcnt(10)
    v_pk_add_f32 v[32:33], v[32:33], v[48:49]
    v_pk_add_f32 v[34:35], v[34:35], v[50:51]
    s_waitcnt lgkmcnt(9)
    v_pk_add_f32 v[32:33], v[32:33], v[80:81]
    v_pk_add_f32 v[34:35], v[34:35], v[82:83]
    s_waitcnt lgkmcnt(8)
    v_pk_add_f32 v[36:37], v[36:37], v[68:69]
    v_pk_add_f32 v[38:39], v[38:39], v[70:71]
    s_waitcnt lgkmcnt(7)
    v_pk_add_f32 v[36:37], v[36:37], v[52:53]
    v_pk_add_f32 v[38:39], v[38:39], v[54:55]
    s_waitcnt lgkmcnt(6)
    v_pk_add_f32 v[36:37], v[36:37], v[84:85]
    v_pk_add_f32 v[38:39], v[38:39], v[86:87]
    s_waitcnt lgkmcnt(5)
    v_pk_add_f32 v[40:41], v[40:41], v[72:73]
    v_pk_add_f32 v[42:43], v[42:43], v[74:75]
    s_waitcnt lgkmcnt(4)
    v_pk_add_f32 v[40:41], v[40:41], v[56:57]
    v_pk_add_f32 v[42:43], v[42:43], v[58:59]
    s_waitcnt lgkmcnt(3)
    v_pk_add_f32 v[40:41], v[40:41], v[88:89]
    v_pk_add_f32 v[42:43], v[42:43], v[90:91]
    s_waitcnt lgkmcnt(2)
    v_pk_add_f32 v[44:45], v[44:45], v[76:77]
    v_pk_add_f32 v[46:47], v[46:47], v[78:79]
    s_waitcnt lgkmcnt(1)
    v_pk_add_f32 v[44:45], v[44:45], v[60:61]
    v_pk_add_f32 v[46:47], v[46:47], v[62:63]
    s_waitcnt lgkmcnt(0)
    v_pk_add_f32 v[44:45], v[44:45], v[92:93]
    v_pk_add_f32 v[46:47], v[46:47], v[94:95]
    s_waitcnt vmcnt(14)
    v_pk_add_f32 v[32:33], v[32:33], v[96:97]
    s_waitcnt vmcnt(12)
    v_pk_add_f32 v[34:35], v[34:35], v[98:99]
    v_cvt_pk_bf16_f32 v112, v32, v33
    v_cvt_pk_bf16_f32 v113, v34, v35
    s_waitcnt vmcnt(10)
    v_pk_add_f32 v[36:37], v[36:37], v[100:101]
    s_waitcnt vmcnt(8)
    v_pk_add_f32 v[38:39], v[38:39], v[102:103]
    v_cvt_pk_bf16_f32 v114, v36, v37
    v_cvt_pk_bf16_f32 v115, v38, v39
    s_nop 0
    v_permlane32_swap_b32 v112, v114
    v_permlane32_swap_b32 v113, v115
    buffer_store_dwordx4 v[112:115], v149, s[52:55], 0 offen offset:0
    s_waitcnt vmcnt(7)
    v_pk_add_f32 v[40:41], v[40:41], v[104:105]
    s_waitcnt vmcnt(5)
    v_pk_add_f32 v[42:43], v[42:43], v[106:107]
    v_cvt_pk_bf16_f32 v116, v40, v41
    v_cvt_pk_bf16_f32 v117, v42, v43
    s_waitcnt vmcnt(3)
    v_pk_add_f32 v[44:45], v[44:45], v[108:109]
    s_waitcnt vmcnt(1)
    v_pk_add_f32 v[46:47], v[46:47], v[110:111]
    v_cvt_pk_bf16_f32 v118, v44, v45
    v_cvt_pk_bf16_f32 v119, v46, v47
    s_nop 0
    v_permlane32_swap_b32 v116, v118
    v_permlane32_swap_b32 v117, v119
    buffer_store_dwordx4 v[116:119], v149, s[52:55], 0 offen offset:32
    s_endpgm
Lln:
    s_lshl_b32 s70, s58, 1
    s_add_u32 s70, s70, s59
    s_sub_u32 s70, s70, 14
    v_lshrrev_b32 v10, 3, v1
    v_and_b32 v11, 7, v1
    v_lshlrev_b32 v12, 4, v11
    v_lshl_add_u32 v12, v10, 10, v12
    v_add_u32 v13, 8192, v12
    s_lshl_b32 s63, s70, 16
    s_lshl_b32 s62, s57, 14
    s_add_u32 s63, s63, s62
    v_and_b32 v157, 3, v1
    v_lshlrev_b32 v157, 2, v157
    v_add_u32 v157, 157440, v157
    s_lshl2_add_u32 s61, s57, 157440
    v_mov_b32 v158, s61
    v_mov_b32 v159, 16
    ds_write2_b32 v158, v159, v159 offset0:16 offset1:20
    s_waitcnt lgkmcnt(0)
    s_mov_b32 s36, s4
    s_mov_b32 s37, s5
    s_mov_b32 s38, 0x200000
    s_mov_b32 s39, 0x00020000
    buffer_load_dwordx4 v[32:35], v12, s[36:39], s63 offen offset:0
    buffer_load_dwordx4 v[36:39], v12, s[36:39], s63 offen offset:128
    buffer_load_dwordx4 v[40:43], v12, s[36:39], s63 offen offset:256
    buffer_load_dwordx4 v[44:47], v12, s[36:39], s63 offen offset:384
    buffer_load_dwordx4 v[48:51], v12, s[36:39], s63 offen offset:512
    buffer_load_dwordx4 v[52:55], v12, s[36:39], s63 offen offset:640
    buffer_load_dwordx4 v[56:59], v12, s[36:39], s63 offen offset:768
    buffer_load_dwordx4 v[60:63], v12, s[36:39], s63 offen offset:896
    buffer_load_dwordx4 v[64:67], v13, s[36:39], s63 offen offset:0
    buffer_load_dwordx4 v[68:71], v13, s[36:39], s63 offen offset:128
    buffer_load_dwordx4 v[72:75], v13, s[36:39], s63 offen offset:256
    buffer_load_dwordx4 v[76:79], v13, s[36:39], s63 offen offset:384
    buffer_load_dwordx4 v[80:83], v13, s[36:39], s63 offen offset:512
    buffer_load_dwordx4 v[84:87], v13, s[36:39], s63 offen offset:640
    buffer_load_dwordx4 v[88:91], v13, s[36:39], s63 offen offset:768
    buffer_load_dwordx4 v[92:95], v13, s[36:39], s63 offen offset:896
    s_mov_b32 s48, s32
    s_mov_b32 s49, s33
    s_mov_b32 s50, 0x10000000
    s_mov_b32 s51, 0x00020000
    s_load_dword s60, s[32:33], 0x10000
    s_barrier
    s_lshr_b32 s61, s63, 6
    v_lshlrev_b32 v15, 4, v10
    v_add_u32 v15, s61, v15
    s_lshr_b32 s61, s70, 3
    s_lshl_b32 s61, s61, 12
    s_and_b32 s62, s70, 7
    s_lshl_b32 s63, s62, 7
    s_add_u32 s63, s63, s61
    s_lshl_b32 s64, s57, 5
    s_add_u32 s63, s63, s64
    s_add_u32 s63, s63, 0x50000
    v_lshrrev_b32 v16, 1, v10
    v_lshlrev_b32 v16, 10, v16
    v_and_b32 v17, 1, v10
    v_lshl_add_u32 v16, v17, 3, v16
    v_add_u32 v16, s63, v16
    s_lshr_b32 s61, s61, 1
    s_lshl2_add_u32 s62, s62, s57
    s_lshl2_add_u32 s61, s62, s61
    s_add_u32 s61, s61, 0x40000
    v_lshlrev_b32 v29, 7, v1
    v_add_u32 v29, s61, v29
    v_lshrrev_b32 v154, 5, v1
    v_bfe_u32 v155, v1, 2, 2
    v_lshl_add_u32 v154, v154, 2, v155
    v_lshlrev_b32 v154, 7, v154
    v_bfe_u32 v155, v1, 3, 1
    s_and_b32 s61, s57, 1
    v_xor_b32 v155, s61, v155
    v_lshl_add_u32 v154, v155, 6, v154
    v_bfe_u32 v155, v1, 4, 1
    v_lshl_add_u32 v154, v155, 5, v154
    v_and_b32 v155, 3, v1
    v_lshl_add_u32 v154, v155, 3, v154
    s_lshl_b32 s61, s57, 13
    v_add_u32 v144, s61, v154
    v_xor_b32 v145, 64, v144
    v_add_u32 v146, 0x10000, v144
    v_add_u32 v147, 0x10000, v145
    s_mov_b32 s44, s24
    s_mov_b32 s45, s25
    s_mov_b32 s46, 0x1c0000
    s_mov_b32 s47, 0x00020000
    v_lshrrev_b32 v154, 3, v1
    v_and_b32 v155, 7, v1
    v_bfe_u32 v156, v1, 4, 1
    v_lshlrev_b32 v156, 2, v156
    v_xor_b32 v155, v155, v156
    v_lshlrev_b32 v155, 4, v155
    v_lshl_add_u32 v0, v154, 10, v155
    v_add_u32 v148, 7168, v0
    v_add_u32 v149, 14336, v0
    v_add_u32 v150, 21504, v0
    s_mul_i32 s34, s57, 458752
    s_lshl_b32 s77, s69, 7
    s_add_u32 s34, s34, s77
    s_add_u32 s35, s34, 458752
    s_lshl_b32 s76, s100, 16
    s_add_u32 s76, s76, s34
    s_lshl_b32 s77, s57, 13
    s_lshr_b32 s61, s57, 1
    s_mul_i32 s62, s61, 114688
    s_sub_u32 s63, 114688, s62
    v_lshlrev_b32 v156, 4, v1
    v_add_u32 v152, s62, v156
    v_add_u32 v151, s63, v156
    s_waitcnt lgkmcnt(0)
    s_mov_b32 s64, 0x3f803f80
    v_mov_b32 v96, 0
    v_mov_b32 v97, 0
    v_mov_b32 v98, 0
    v_mov_b32 v99, 0
    s_add_u32 s60, s60, 1
    s_waitcnt vmcnt(15)
    v_dot2c_f32_bf16 v96, s64, v32
    v_dot2c_f32_bf16 v98, v32, v32
    v_mov_b32 v100, 0
    v_mov_b32 v102, 0
    v_dot2c_f32_bf16 v100, s64, v33
    v_dot2c_f32_bf16 v102, v33, v33
    v_dot2c_f32_bf16 v96, s64, v34
    v_dot2c_f32_bf16 v98, v34, v34
    v_dot2c_f32_bf16 v100, s64, v35
    v_dot2c_f32_bf16 v102, v35, v35
    s_waitcnt vmcnt(14)
    v_dot2c_f32_bf16 v96, s64, v36
    v_dot2c_f32_bf16 v98, v36, v36
    v_dot2c_f32_bf16 v100, s64, v37
    v_dot2c_f32_bf16 v102, v37, v37
    v_dot2c_f32_bf16 v96, s64, v38
    v_dot2c_f32_bf16 v98, v38, v38
    v_dot2c_f32_bf16 v100, s64, v39
    v_dot2c_f32_bf16 v102, v39, v39
    s_waitcnt vmcnt(13)
    v_dot2c_f32_bf16 v96, s64, v40
    v_dot2c_f32_bf16 v98, v40, v40
    v_dot2c_f32_bf16 v100, s64, v41
    v_dot2c_f32_bf16 v102, v41, v41
    v_dot2c_f32_bf16 v96, s64, v42
    v_dot2c_f32_bf16 v98, v42, v42
    v_dot2c_f32_bf16 v100, s64, v43
    v_dot2c_f32_bf16 v102, v43, v43
    s_waitcnt vmcnt(12)
    v_dot2c_f32_bf16 v96, s64, v44
    v_dot2c_f32_bf16 v98, v44, v44
    v_dot2c_f32_bf16 v100, s64, v45
    v_dot2c_f32_bf16 v102, v45, v45
    v_dot2c_f32_bf16 v96, s64, v46
    v_dot2c_f32_bf16 v98, v46, v46
    v_dot2c_f32_bf16 v100, s64, v47
    v_dot2c_f32_bf16 v102, v47, v47
    s_waitcnt vmcnt(11)
    v_dot2c_f32_bf16 v96, s64, v48
    v_dot2c_f32_bf16 v98, v48, v48
    v_dot2c_f32_bf16 v100, s64, v49
    v_dot2c_f32_bf16 v102, v49, v49
    v_dot2c_f32_bf16 v96, s64, v50
    v_dot2c_f32_bf16 v98, v50, v50
    v_dot2c_f32_bf16 v100, s64, v51
    v_dot2c_f32_bf16 v102, v51, v51
    s_waitcnt vmcnt(10)
    v_dot2c_f32_bf16 v96, s64, v52
    v_dot2c_f32_bf16 v98, v52, v52
    v_dot2c_f32_bf16 v100, s64, v53
    v_dot2c_f32_bf16 v102, v53, v53
    v_dot2c_f32_bf16 v96, s64, v54
    v_dot2c_f32_bf16 v98, v54, v54
    v_dot2c_f32_bf16 v100, s64, v55
    v_dot2c_f32_bf16 v102, v55, v55
    s_waitcnt vmcnt(9)
    v_dot2c_f32_bf16 v96, s64, v56
    v_dot2c_f32_bf16 v98, v56, v56
    v_dot2c_f32_bf16 v100, s64, v57
    v_dot2c_f32_bf16 v102, v57, v57
    v_dot2c_f32_bf16 v96, s64, v58
    v_dot2c_f32_bf16 v98, v58, v58
    v_dot2c_f32_bf16 v100, s64, v59
    v_dot2c_f32_bf16 v102, v59, v59
    s_waitcnt vmcnt(8)
    v_dot2c_f32_bf16 v96, s64, v60
    v_dot2c_f32_bf16 v98, v60, v60
    v_dot2c_f32_bf16 v100, s64, v61
    v_dot2c_f32_bf16 v102, v61, v61
    v_dot2c_f32_bf16 v96, s64, v62
    v_dot2c_f32_bf16 v98, v62, v62
    v_dot2c_f32_bf16 v100, s64, v63
    v_dot2c_f32_bf16 v102, v63, v63
    s_waitcnt vmcnt(7)
    v_dot2c_f32_bf16 v97, s64, v64
    v_dot2c_f32_bf16 v99, v64, v64
    v_mov_b32 v101, 0
    v_mov_b32 v103, 0
    v_dot2c_f32_bf16 v101, s64, v65
    v_dot2c_f32_bf16 v103, v65, v65
    v_dot2c_f32_bf16 v97, s64, v66
    v_dot2c_f32_bf16 v99, v66, v66
    v_dot2c_f32_bf16 v101, s64, v67
    v_dot2c_f32_bf16 v103, v67, v67
    s_waitcnt vmcnt(6)
    v_dot2c_f32_bf16 v97, s64, v68
    v_dot2c_f32_bf16 v99, v68, v68
    v_dot2c_f32_bf16 v101, s64, v69
    v_dot2c_f32_bf16 v103, v69, v69
    v_dot2c_f32_bf16 v97, s64, v70
    v_dot2c_f32_bf16 v99, v70, v70
    v_dot2c_f32_bf16 v101, s64, v71
    v_dot2c_f32_bf16 v103, v71, v71
    s_waitcnt vmcnt(5)
    v_dot2c_f32_bf16 v97, s64, v72
    v_dot2c_f32_bf16 v99, v72, v72
    v_dot2c_f32_bf16 v101, s64, v73
    v_dot2c_f32_bf16 v103, v73, v73
    v_dot2c_f32_bf16 v97, s64, v74
    v_dot2c_f32_bf16 v99, v74, v74
    v_dot2c_f32_bf16 v101, s64, v75
    v_dot2c_f32_bf16 v103, v75, v75
    s_waitcnt vmcnt(4)
    v_dot2c_f32_bf16 v97, s64, v76
    v_dot2c_f32_bf16 v99, v76, v76
    v_dot2c_f32_bf16 v101, s64, v77
    v_dot2c_f32_bf16 v103, v77, v77
    v_dot2c_f32_bf16 v97, s64, v78
    v_dot2c_f32_bf16 v99, v78, v78
    v_dot2c_f32_bf16 v101, s64, v79
    v_dot2c_f32_bf16 v103, v79, v79
    s_waitcnt vmcnt(3)
    v_dot2c_f32_bf16 v97, s64, v80
    v_dot2c_f32_bf16 v99, v80, v80
    v_dot2c_f32_bf16 v101, s64, v81
    v_dot2c_f32_bf16 v103, v81, v81
    v_dot2c_f32_bf16 v97, s64, v82
    v_dot2c_f32_bf16 v99, v82, v82
    v_dot2c_f32_bf16 v101, s64, v83
    v_dot2c_f32_bf16 v103, v83, v83
    s_waitcnt vmcnt(2)
    v_dot2c_f32_bf16 v97, s64, v84
    v_dot2c_f32_bf16 v99, v84, v84
    v_dot2c_f32_bf16 v101, s64, v85
    v_dot2c_f32_bf16 v103, v85, v85
    v_dot2c_f32_bf16 v97, s64, v86
    v_dot2c_f32_bf16 v99, v86, v86
    v_dot2c_f32_bf16 v101, s64, v87
    v_dot2c_f32_bf16 v103, v87, v87
    s_waitcnt vmcnt(1)
    v_dot2c_f32_bf16 v97, s64, v88
    v_dot2c_f32_bf16 v99, v88, v88
    v_dot2c_f32_bf16 v101, s64, v89
    v_dot2c_f32_bf16 v103, v89, v89
    v_dot2c_f32_bf16 v97, s64, v90
    v_dot2c_f32_bf16 v99, v90, v90
    v_dot2c_f32_bf16 v101, s64, v91
    v_dot2c_f32_bf16 v103, v91, v91
    s_waitcnt vmcnt(0)
    v_dot2c_f32_bf16 v97, s64, v92
    v_dot2c_f32_bf16 v99, v92, v92
    v_dot2c_f32_bf16 v101, s64, v93
    v_dot2c_f32_bf16 v103, v93, v93
    v_dot2c_f32_bf16 v97, s64, v94
    v_dot2c_f32_bf16 v99, v94, v94
    v_dot2c_f32_bf16 v101, s64, v95
    v_dot2c_f32_bf16 v103, v95, v95
    v_add_f32 v96, v96, v100
    v_add_f32 v98, v98, v102
    v_add_f32 v97, v97, v101
    v_add_f32 v99, v99, v103
    v_add_f32_dpp v96, v96, v96 quad_perm:[1,0,3,2] row_mask:0xf bank_mask:0xf
    v_add_f32_dpp v97, v97, v97 quad_perm:[1,0,3,2] row_mask:0xf bank_mask:0xf
    v_add_f32_dpp v98, v98, v98 quad_perm:[1,0,3,2] row_mask:0xf bank_mask:0xf
    v_add_f32_dpp v99, v99, v99 quad_perm:[1,0,3,2] row_mask:0xf bank_mask:0xf
    v_add_f32_dpp v96, v96, v96 quad_perm:[2,3,0,1] row_mask:0xf bank_mask:0xf
    v_add_f32_dpp v97, v97, v97 quad_perm:[2,3,0,1] row_mask:0xf bank_mask:0xf
    v_add_f32_dpp v98, v98, v98 quad_perm:[2,3,0,1] row_mask:0xf bank_mask:0xf
    v_add_f32_dpp v99, v99, v99 quad_perm:[2,3,0,1] row_mask:0xf bank_mask:0xf
    v_add_f32_dpp v96, v96, v96 row_half_mirror row_mask:0xf bank_mask:0xf
    v_add_f32_dpp v97, v97, v97 row_half_mirror row_mask:0xf bank_mask:0xf
    v_add_f32_dpp v98, v98, v98 row_half_mirror row_mask:0xf bank_mask:0xf
    v_add_f32_dpp v99, v99, v99 row_half_mirror row_mask:0xf bank_mask:0xf
    s_mov_b32 s61, 0x3b000000
    s_mov_b32 s62, 0x3727c5ac
    v_mul_f32 v110, s61, v96
    v_mul_f32 v122, s61, v97
    v_mul_f32 v111, s61, v98
    v_mul_f32 v123, s61, v99
    v_fma_f32 v111, -v110, v110, v111
    v_fma_f32 v123, -v122, v122, v123
    v_max_f32 v111, 0, v111
    v_max_f32 v123, 0, v123
    v_cvt_pk_bf16_f32 v114, v110, v110
    v_cvt_pk_bf16_f32 v126, v122, v122
    v_and_b32 v114, 0xffff0000, v114
    v_and_b32 v126, 0xffff0000, v126
    v_cvt_pk_bf16_f32 v112, v111, v111
    v_cvt_pk_bf16_f32 v124, v123, v123
    v_and_b32 v112, 0xffff0000, v112
    v_and_b32 v124, 0xffff0000, v124
    v_add_f32 v112, s62, v112
    v_add_f32 v124, s62, v124
    v_cvt_pk_bf16_f32 v112, v112, v112
    v_cvt_pk_bf16_f32 v124, v124, v124
    v_and_b32 v112, 0xffff0000, v112
    v_and_b32 v124, 0xffff0000, v124
    v_sqrt_f32 v112, v112
    v_sqrt_f32 v124, v124
    v_cvt_pk_bf16_f32 v112, v112, v112
    v_cvt_pk_bf16_f32 v124, v124, v124
    v_and_b32 v112, 0xffff0000, v112
    v_and_b32 v124, 0xffff0000, v124
    v_rcp_f32 v108, v112
    v_rcp_f32 v120, v124
    v_mul_f32 v113, v111, v108
    v_mul_f32 v125, v123, v120
    v_mul_f32 v113, v113, v108
    v_mul_f32 v125, v125, v120
    v_cvt_pk_bf16_f32 v113, v113, v113
    v_cvt_pk_bf16_f32 v125, v125, v125
    v_and_b32 v113, 0xffff0000, v113
    v_and_b32 v125, 0xffff0000, v125
    v_add_f32 v113, s62, v113
    v_add_f32 v125, s62, v125
    v_cvt_pk_bf16_f32 v113, v113, v113
    v_cvt_pk_bf16_f32 v125, v125, v125
    v_and_b32 v113, 0xffff0000, v113
    v_and_b32 v125, 0xffff0000, v125
    v_sqrt_f32 v113, v113
    v_sqrt_f32 v125, v125
    v_cvt_pk_bf16_f32 v113, v113, v113
    v_cvt_pk_bf16_f32 v125, v125, v125
    v_and_b32 v113, 0xffff0000, v113
    v_and_b32 v125, 0xffff0000, v125
    v_rcp_f32 v113, v113
    v_rcp_f32 v125, v125
    v_mul_f32 v109, -v114, v108
    v_mul_f32 v121, -v126, v120
    v_mul_f32 v104, v108, v113
    v_mul_f32 v116, v120, v125
    v_mul_f32 v105, -v110, v104
    v_mul_f32 v117, -v122, v116
    v_mov_b32 v106, s60
    v_mov_b32 v118, s60
    v_mov_b32 v107, 0
    v_mov_b32 v119, 0
    s_mov_b32 exec_lo, 0x01010101
    s_mov_b32 exec_hi, 0x01010101
    buffer_store_dwordx2 v[108:109], v16, s[48:51], 0 offen offset:0 sc1
    buffer_store_dwordx2 v[120:121], v16, s[48:51], 0 offen offset:16 sc1
    buffer_store_dwordx4 v[104:107], v15, s[48:51], 0 offen offset:0 sc1
    buffer_store_dwordx4 v[116:119], v15, s[48:51], 0 offen offset:128 sc1
    s_mov_b64 exec, -1
    v_mov_b32 v11, s60
    s_mov_b64 exec, 0xffff
    s_waitcnt vmcnt(2)
    buffer_store_dword v11, v29, s[48:51], 0 offen sc1
    s_mov_b64 exec, -1
    ds_read_b32 v27, v157 offset:112
    s_waitcnt lgkmcnt(0)
    v_cmp_gt_u32 vcc, 1, v27
    s_nop 0
    s_cbranch_vccnz Lvp58
Lvk59:
    s_add_u32 m0, s77, 0
    s_nop 0
    buffer_load_dwordx4 v0, s[44:47], s76 offen offset:0 lds
    buffer_load_dwordx4 v148, s[44:47], s76 offen offset:1024 lds
    buffer_load_dwordx4 v149, s[44:47], s76 offen offset:2048 lds
    buffer_load_dwordx4 v150, s[44:47], s76 offen offset:3072 lds
    s_add_u32 m0, s77, 4096
    s_add_u32 s78, s76, 32768
    buffer_load_dwordx4 v0, s[44:47], s78 offen offset:0 lds
    buffer_load_dwordx4 v148, s[44:47], s78 offen offset:1024 lds
    buffer_load_dwordx4 v149, s[44:47], s78 offen offset:2048 lds
    buffer_load_dwordx4 v150, s[44:47], s78 offen offset:3072 lds
    s_add_u32 s76, s76, 65536
    s_cmp_eq_u32 s76, s35
    s_cselect_b32 s76, s34, s76
    s_add_u32 m0, s77, 32768
    s_nop 0
    buffer_load_dwordx4 v0, s[44:47], s76 offen offset:0 lds
    buffer_load_dwordx4 v148, s[44:47], s76 offen offset:1024 lds
    buffer_load_dwordx4 v149, s[44:47], s76 offen offset:2048 lds
    buffer_load_dwordx4 v150, s[44:47], s76 offen offset:3072 lds
    s_add_u32 m0, s77, 36864
    s_add_u32 s78, s76, 32768
    buffer_load_dwordx4 v0, s[44:47], s78 offen offset:0 lds
    buffer_load_dwordx4 v148, s[44:47], s78 offen offset:1024 lds
    buffer_load_dwordx4 v149, s[44:47], s78 offen offset:2048 lds
    buffer_load_dwordx4 v150, s[44:47], s78 offen offset:3072 lds
    s_add_u32 s76, s76, 65536
    s_cmp_eq_u32 s76, s35
    s_cselect_b32 s76, s34, s76
    s_add_u32 m0, s77, 65536
    s_nop 0
    buffer_load_dwordx4 v0, s[44:47], s76 offen offset:0 lds
    buffer_load_dwordx4 v148, s[44:47], s76 offen offset:1024 lds
    buffer_load_dwordx4 v149, s[44:47], s76 offen offset:2048 lds
    buffer_load_dwordx4 v150, s[44:47], s76 offen offset:3072 lds
    s_add_u32 m0, s77, 69632
    s_add_u32 s78, s76, 32768
    buffer_load_dwordx4 v0, s[44:47], s78 offen offset:0 lds
    buffer_load_dwordx4 v148, s[44:47], s78 offen offset:1024 lds
    buffer_load_dwordx4 v149, s[44:47], s78 offen offset:2048 lds
    buffer_load_dwordx4 v150, s[44:47], s78 offen offset:3072 lds
    s_add_u32 s76, s76, 65536
    s_cmp_eq_u32 s76, s35
    s_cselect_b32 s76, s34, s76
    s_add_u32 m0, s77, 98304
    s_nop 0
    buffer_load_dwordx4 v0, s[44:47], s76 offen offset:0 lds
    buffer_load_dwordx4 v148, s[44:47], s76 offen offset:1024 lds
    buffer_load_dwordx4 v149, s[44:47], s76 offen offset:2048 lds
    buffer_load_dwordx4 v150, s[44:47], s76 offen offset:3072 lds
    s_lshl_b32 s10, s69, 7
    v_lshl_add_u32 v4, v1, 2, s10
    s_mov_b32 m0, 159616
    s_mov_b32 exec_hi, 0
    global_load_lds_dword v4, s[26:27]
    s_mov_b32 exec_hi, -1
    s_waitcnt vmcnt(13)
    ds_read_b64_tr_b16 a[0:1], v144 offset:0
    ds_read_b64_tr_b16 a[2:3], v144 offset:1024
    ds_read_b64_tr_b16 a[4:5], v145 offset:0
    ds_read_b64_tr_b16 a[6:7], v145 offset:1024
    ds_read_b64_tr_b16 a[8:9], v144 offset:2048
    ds_read_b64_tr_b16 a[10:11], v144 offset:3072
    ds_read_b64_tr_b16 a[12:13], v145 offset:2048
    ds_read_b64_tr_b16 a[14:15], v145 offset:3072
    ds_read_b64_tr_b16 a[16:17], v144 offset:4096
    ds_read_b64_tr_b16 a[18:19], v144 offset:5120
    ds_read_b64_tr_b16 a[20:21], v145 offset:4096
    ds_read_b64_tr_b16 a[22:23], v145 offset:5120
    ds_read_b64_tr_b16 a[24:25], v144 offset:6144
    ds_read_b64_tr_b16 a[26:27], v144 offset:7168
    ds_read_b64_tr_b16 a[28:29], v145 offset:6144
    ds_read_b64_tr_b16 a[30:31], v145 offset:7168
    ds_read_b64_tr_b16 a[32:33], v144 offset:32768
    ds_read_b64_tr_b16 a[34:35], v144 offset:33792
    ds_read_b64_tr_b16 a[36:37], v145 offset:32768
    ds_read_b64_tr_b16 a[38:39], v145 offset:33792
    ds_read_b64_tr_b16 a[40:41], v144 offset:34816
    ds_read_b64_tr_b16 a[42:43], v144 offset:35840
    ds_read_b64_tr_b16 a[44:45], v145 offset:34816
    ds_read_b64_tr_b16 a[46:47], v145 offset:35840
    ds_read_b64_tr_b16 a[48:49], v144 offset:36864
    ds_read_b64_tr_b16 a[50:51], v144 offset:37888
    ds_read_b64_tr_b16 a[52:53], v145 offset:36864
    ds_read_b64_tr_b16 a[54:55], v145 offset:37888
    ds_read_b64_tr_b16 a[56:57], v144 offset:38912
    ds_read_b64_tr_b16 a[58:59], v144 offset:39936
    ds_read_b64_tr_b16 a[60:61], v145 offset:38912
    ds_read_b64_tr_b16 a[62:63], v145 offset:39936
    s_waitcnt lgkmcnt(0)
    s_add_u32 m0, s77, 0
    s_add_u32 s78, s76, 32768
    buffer_load_dwordx4 v0, s[44:47], s78 offen offset:0 lds
    buffer_load_dwordx4 v148, s[44:47], s78 offen offset:1024 lds
    buffer_load_dwordx4 v149, s[44:47], s78 offen offset:2048 lds
    buffer_load_dwordx4 v150, s[44:47], s78 offen offset:3072 lds
    s_add_u32 s76, s76, 65536
    s_cmp_eq_u32 s76, s35
    s_cselect_b32 s76, s34, s76
    s_add_u32 m0, s77, 4096
    s_nop 0
    buffer_load_dwordx4 v0, s[44:47], s76 offen offset:0 lds
    buffer_load_dwordx4 v148, s[44:47], s76 offen offset:1024 lds
    buffer_load_dwordx4 v149, s[44:47], s76 offen offset:2048 lds
    buffer_load_dwordx4 v150, s[44:47], s76 offen offset:3072 lds
    s_add_u32 m0, s77, 32768
    s_add_u32 s78, s76, 32768
    buffer_load_dwordx4 v0, s[44:47], s78 offen offset:0 lds
    buffer_load_dwordx4 v148, s[44:47], s78 offen offset:1024 lds
    buffer_load_dwordx4 v149, s[44:47], s78 offen offset:2048 lds
    buffer_load_dwordx4 v150, s[44:47], s78 offen offset:3072 lds
    s_add_u32 s76, s76, 65536
    s_cmp_eq_u32 s76, s35
    s_cselect_b32 s76, s34, s76
    s_add_u32 m0, s77, 36864
    s_nop 0
    buffer_load_dwordx4 v0, s[44:47], s76 offen offset:0 lds
    buffer_load_dwordx4 v148, s[44:47], s76 offen offset:1024 lds
    buffer_load_dwordx4 v149, s[44:47], s76 offen offset:2048 lds
    buffer_load_dwordx4 v150, s[44:47], s76 offen offset:3072 lds
    s_waitcnt vmcnt(17)
    ds_read_b64_tr_b16 a[64:65], v146 offset:0
    ds_read_b64_tr_b16 a[66:67], v146 offset:1024
    ds_read_b64_tr_b16 a[68:69], v147 offset:0
    ds_read_b64_tr_b16 a[70:71], v147 offset:1024
    ds_read_b64_tr_b16 a[72:73], v146 offset:2048
    ds_read_b64_tr_b16 a[74:75], v146 offset:3072
    ds_read_b64_tr_b16 a[76:77], v147 offset:2048
    ds_read_b64_tr_b16 a[78:79], v147 offset:3072
    ds_read_b64_tr_b16 a[80:81], v146 offset:4096
    ds_read_b64_tr_b16 a[82:83], v146 offset:5120
    ds_read_b64_tr_b16 a[84:85], v147 offset:4096
    ds_read_b64_tr_b16 a[86:87], v147 offset:5120
    ds_read_b64_tr_b16 a[88:89], v146 offset:6144
    ds_read_b64_tr_b16 a[90:91], v146 offset:7168
    ds_read_b64_tr_b16 a[92:93], v147 offset:6144
    ds_read_b64_tr_b16 a[94:95], v147 offset:7168
    ds_read_b64_tr_b16 v[96:97], v146 offset:32768
    ds_read_b64_tr_b16 v[98:99], v146 offset:33792
    ds_read_b64_tr_b16 v[100:101], v147 offset:32768
    ds_read_b64_tr_b16 v[102:103], v147 offset:33792
    ds_read_b64_tr_b16 v[104:105], v146 offset:34816
    ds_read_b64_tr_b16 v[106:107], v146 offset:35840
    ds_read_b64_tr_b16 v[108:109], v147 offset:34816
    ds_read_b64_tr_b16 v[110:111], v147 offset:35840
    s_waitcnt lgkmcnt(0)
    s_add_u32 m0, s77, 65536
    s_add_u32 s78, s76, 32768
    buffer_load_dwordx4 v0, s[44:47], s78 offen offset:0 lds
    buffer_load_dwordx4 v148, s[44:47], s78 offen offset:1024 lds
    buffer_load_dwordx4 v149, s[44:47], s78 offen offset:2048 lds
    buffer_load_dwordx4 v150, s[44:47], s78 offen offset:3072 lds
    s_add_u32 s76, s76, 65536
    s_cmp_eq_u32 s76, s35
    s_cselect_b32 s76, s34, s76
    s_add_u32 m0, s77, 69632
    s_nop 0
    buffer_load_dwordx4 v0, s[44:47], s76 offen offset:0 lds
    buffer_load_dwordx4 v148, s[44:47], s76 offen offset:1024 lds
    buffer_load_dwordx4 v149, s[44:47], s76 offen offset:2048 lds
    buffer_load_dwordx4 v150, s[44:47], s76 offen offset:3072 lds
    s_add_u32 m0, s77, 98304
    s_add_u32 s78, s76, 32768
    buffer_load_dwordx4 v0, s[44:47], s78 offen offset:0 lds
    buffer_load_dwordx4 v148, s[44:47], s78 offen offset:1024 lds
    buffer_load_dwordx4 v149, s[44:47], s78 offen offset:2048 lds
    buffer_load_dwordx4 v150, s[44:47], s78 offen offset:3072 lds
    s_waitcnt vmcnt(0) lgkmcnt(0)
    s_branch Lg2
Lhelper:
    s_lshr_b32 s76, s57, 1
    s_and_b32 s77, s57, 1
    s_lshl1_add_u32 s78, s2, s76
    v_lshrrev_b32 v41, 2, v1
    v_and_b32 v42, 3, v1
    v_lshlrev_b32 v43, 4, v42
    v_lshl_add_u32 v45, v41, 10, v43
    s_lshl_b32 s61, s78, 8
    s_lshl_b32 s62, s77, 7
    s_add_u32 s61, s61, s62
    v_lshl_add_u32 v46, v1, 1, s61
    v_mov_b32 v2, 0
    v_mov_b32 v3, 0
    v_mov_b32 v4, 0
    v_mov_b32 v5, 0
    s_lshl2_add_u32 s61, s58, s57
    s_lshl_b32 s79, s61, 15
    s_lshl_b32 s62, s59, 6
    s_add_u32 s79, s79, s62
    v_mov_b32 v64, 0
    s_lshl2_add_u32 s61, s57, 157440
    v_mov_b32 v14, s61
    ds_write2_b32 v14, v64, v64 offset0:0 offset1:4
    ds_write2_b32 v14, v64, v64 offset0:8 offset1:12
    ds_write_b32 v14, v64 offset:112
    s_xor_b32 s61, s61, 4
    v_mov_b32 v15, s61
    s_mul_i32 s63, s76, 8320
    s_add_u32 s63, s63, 131072
    s_mul_i32 s62, s77, 4160
    s_add_u32 s72, s62, s63
    s_mov_b32 m0, s72
    v_and_b32 v44, 15, v1
    v_lshl_add_u32 v47, v44, 2, s72
    ds_write_b32 v47, v64 offset:4096
    s_mul_i32 s64, s76, 4608
    s_add_u32 s64, s64, 147712
    s_lshl_b32 s62, s77, 8
    s_add_u32 s62, s62, s64
    v_lshl_add_u32 v47, v1, 2, s62
    ds_write_b32 v47, v64
    v_lshlrev_b32 v10, 4, v1
    s_waitcnt lgkmcnt(0)
    s_mov_b32 s36, s4
    s_mov_b32 s37, s5
    s_mov_b32 s38, 0x200000
    s_mov_b32 s39, 0x00020000
    buffer_load_dwordx4 v45, s[36:39], s79 offen lds
    s_add_u32 m0, m0, 1024
    s_add_u32 s79, s79, 16384
    buffer_load_dwordx4 v45, s[36:39], s79 offen lds
    global_load_short_d16_hi v2, v46, s[6:7]
    global_load_short_d16_hi v3, v46, s[8:9]
    global_load_short_d16_hi v4, v46, s[10:11]
    global_load_short_d16_hi v5, v46, s[12:13]
    s_lshl_b32 s61, s2, 2
    s_load_dword s70, s[14:15], s61
    s_load_dword s71, s[16:17], s61
    s_mov_b32 s48, s32
    s_mov_b32 s49, s33
    s_mov_b32 s50, 0x10000000
    s_mov_b32 s51, 0x00020000
    s_load_dword s60, s[32:33], 0x10000
    s_barrier
    s_mov_b32 s44, s24
    s_mov_b32 s45, s25
    s_mov_b32 s46, 0x1c0000
    s_mov_b32 s47, 0x00020000
    v_lshrrev_b32 v40, 4, v1
    v_mov_b32 v16, 1
    v_and_b32 v47, 3, v41
    v_lshl_add_u32 v47, v40, 3, v47
    v_lshlrev_b32 v47, 6, v47
    v_lshl_add_u32 v47, v42, 3, v47
    v_add_u32 v7, s72, v47
    s_lshl2_add_u32 s61, s58, s57
    s_lshl_b32 s62, s59, 10
    s_add_u32 s62, s62, s61
    s_lshl_b32 s62, s62, 7
    s_add_u32 s62, s62, 0x100000
    v_lshrrev_b32 v47, 1, v44
    v_lshlrev_b32 v47, 13, v47
    v_and_b32 v48, 1, v1
    v_lshl_add_u32 v47, v48, 6, v47
    v_lshl_add_u32 v47, v40, 4, v47
    v_add_u32 v8, s62, v47
    s_lshl_b32 s62, s59, 8
    s_lshl2_add_u32 s62, s61, s62
    s_add_u32 s62, s62, 0x44000
    v_mov_b32 v9, s62
    s_and_b32 s61, s2, 15
    s_lshl4_add_u32 s61, s57, s61
    s_lshl_b32 s61, s61, 7
    s_add_u32 s61, s61, 0x40000
    v_lshl_add_u32 v47, v1, 2, s61
    s_lshr_b32 s61, s2, 4
    s_lshl2_add_u32 s61, s61, s57
    s_lshl_b32 s61, s61, 6
    s_add_u32 s61, s61, 0x44000
    v_lshl_add_u32 v48, v44, 2, s61
    v_cmp_gt_u32 vcc, 32, v1
    s_nop 1
    v_cndmask_b32 v36, v48, v47, vcc
    s_lshl2_add_u32 s61, s2, s57
    s_lshl_b32 s61, s61, 11
    s_add_u32 s61, s61, 0x100000
    v_lshl_add_u32 v47, v41, 7, v43
    v_add_u32 v38, s61, v47
    s_lshl_b32 s61, s57, 10
    s_add_u32 s61, s61, 148224
    v_add_u32 v11, s61, v10
    v_lshlrev_b32 v47, 2, v42
    v_add_u32 v13, 157440, v47
    v_add_u32 v47, 32, v13
    v_cndmask_b32 v12, v15, v47, vcc
    s_lshl_b32 s62, s77, 11
    s_add_u32 s62, s62, s63
    v_lshl_add_u32 v26, v1, 5, s62
    v_lshlrev_b32 v45, 3, v40
    v_sub_u32 v45, v45, v44
    v_add_u32 v45, 2031, v45
    v_lshrrev_b32 v45, 1, v45
    v_lshlrev_b32 v45, 2, v45
    v_and_b32 v46, 1, v44
    v_xor_b32 v46, 1, v46
    v_mul_u32_u24 v46, 4160, v46
    v_add_u32 v45, v45, v46
    s_lshl_b32 s62, s77, 6
    s_sub_u32 s61, s63, s62
    s_sub_u32 s61, s61, 896
    v_add_u32 v28, s61, v45
    v_subrev_u32 v29, 1024, v28
    v_subrev_u32 v30, 2048, v28
    v_subrev_u32 v31, 3072, v28
    v_lshlrev_b32 v45, 4, v40
    v_lshl_add_u32 v45, v44, 5, v45
    s_sub_u32 s62, s64, s62
    s_add_u32 s62, s62, 96
    v_add_u32 v32, s62, v45
    s_lshl1_add_u32 s62, s78, s77
    s_lshl_b32 s62, s62, 11
    s_add_u32 s62, s62, 0x300000
    v_lshlrev_b32 v45, 3, v40
    v_lshl_add_u32 v45, v44, 5, v45
    v_add_u32 v35, s62, v45
    s_lshl_b32 s61, s57, 13
    s_add_u32 s61, s61, 102400
    v_add_u32 v33, s61, v10
    v_xor_b32 v34, 8192, v33
    s_add_u32 s73, s72, 2048
    v_lshrrev_b32 v45, 1, v40
    v_and_b32 v46, 1, v40
    v_lshlrev_b32 v47, 9, v45
    v_lshl_add_u32 v47, v46, 4, v47
    v_lshl_add_u32 v47, v44, 5, v47
    v_add_u32 v18, s73, v47
    v_sub_u32 v47, 4, v45
    v_lshlrev_b32 v47, v47, v44
    v_lshl_add_u32 v47, v40, 8, v47
    v_add_u32 v47, s73, v47
    v_add_u32 v19, 1024, v47
    v_mul_u32_u24 v48, 120, v45
    v_add_u32 v48, 8, v48
    v_add_u32 v20, v19, v48
    v_lshlrev_b32 v47, 2, v44
    v_lshl_add_u32 v47, v40, 8, v47
    s_lshl_b32 s73, s76, 10
    s_add_u32 s73, s73, 157568
    s_mul_i32 s62, s77, 4160
    s_add_u32 s62, s62, s73
    v_add_u32 v21, s62, v47
    v_and_b32 v45, 7, v44
    v_lshrrev_b32 v46, 3, v44
    v_lshl_add_u32 v45, v46, 7, v45
    v_cvt_f32_u32 v22, v45
    v_lshlrev_b32 v45, 7, v44
    v_add_u32 v45, 1024, v45
    v_cvt_f32_u32 v24, v45
    v_lshlrev_b32 v45, 3, v44
    v_cvt_f32_u32 v25, v45
    v_lshrrev_b32 v45, 2, v44
    v_lshlrev_b32 v48, 7, v45
    v_lshl_add_u32 v48, v42, 1, v48
    v_add_u32 v48, 256, v48
    v_lshlrev_b32 v45, 8, v45
    v_lshrrev_b32 v49, 1, v42
    v_lshl_add_u32 v45, v49, 7, v45
    v_and_b32 v49, 1, v42
    v_lshl_add_u32 v45, v49, 2, v45
    v_cmp_eq_u32 vcc, 0, v46
    s_nop 1
    v_cndmask_b32 v45, v45, v48, vcc
    v_cvt_f32_u32 v23, v45
    s_lshl_b32 s61, s77, 10
    s_sub_u32 s61, 2047, s61
    v_sub_u32 v45, s61, v10
    v_cmp_eq_u32 s[34:35], 15, v45
    s_sub_u32 s62, s73, 70144
    s_sub_u32 s61, s63, 66048
    s_cmp_eq_u32 s77, 0
    s_cselect_b32 s62, s62, s61
    s_cselect_b32 s61, 512, 0
    s_add_u32 s73, s73, s61
    v_mov_b32 v46, 128
    v_cmp_gt_u32 vcc, v46, v45
    s_nop 1
    v_cndmask_b32 v47, 0, v46, vcc
    v_add_u32 v48, v45, v47
    v_cvt_f32_u32 v69, v48
    v_lshlrev_b32 v47, 2, v47
    v_sub_u32 v68, s62, v47
    v_subrev_u32 v45, 16, v45
    v_max_i32 v45, 0, v45
    v_cmp_gt_u32 vcc, v46, v45
    s_nop 1
    v_cndmask_b32 v47, 0, v46, vcc
    v_add_u32 v48, v45, v47
    v_cvt_f32_u32 v48, v48
    v_lshlrev_b32 v47, 2, v47
    v_cvt_pk_bf16_f32 v48, v48, v48
    v_sub_u32 v47, s62, v47
    v_mad_u32_u16 v39, v48, 4, v47
    s_lshl_b32 s72, s57, 12
    s_add_u32 s72, s72, 0x50000
    s_mul_i32 s79, s2, 7168
    s_lshl_b32 s61, s57, 11
    s_add_u32 s79, s79, s61
    s_waitcnt lgkmcnt(0)
    s_add_u32 s60, s60, 1
    s_lshl_b32 s61, s76, 4
    s_lshr_b32 s70, s70, s61
    s_lshl_b32 s70, s70, 16
    s_lshr_b32 s71, s71, s61
    s_lshl_b32 s71, s71, 16
    v_mov_b32 v45, s71
    v_cndmask_b32 v27, v64, v45, s[34:35]
    s_waitcnt vmcnt(4)
    ds_read_b64_tr_b16 v[40:41], v7 offset:0
    ds_read_b64_tr_b16 v[42:43], v7 offset:256
    ds_read_b64_tr_b16 v[44:45], v7 offset:32
    ds_read_b64_tr_b16 v[46:47], v7 offset:288
    v_mov_b32 v156, s70
    s_lshl2_add_u32 s61, s2, s57
    s_mul_i32 s61, s61, 1792
    v_min_u32 v48, 13, v1
    v_lshlrev_b32 v48, 7, v48
    buffer_load_dword a64, v48, s[44:47], s61 offen
    s_waitcnt vmcnt(4)
    v_mul_f32 v2, 0x3fb8aa3b, v2
    v_mul_f32 v156, 0x3fb8aa3b, v156
    v_exp_f32 v2, v2
    v_exp_f32 v156, v156
    v_cvt_pk_bf16_f32 v2, v2, v2
    v_and_b32 v2, 0xffff0000, v2
    v_cvt_pk_bf16_f32 v156, v156, v156
    v_and_b32 v156, 0xffff0000, v156
    v_mul_f32 v157, 0xbfb8aa3b, v156
    v_mul_f32 v158, 0x3e22f983, v156
    v_add_f32 v159, v156, v156
    v_mul_f32 v2, v157, v2
    s_waitcnt vmcnt(3)
    v_mul_f32 v3, v158, v3
    s_waitcnt vmcnt(2)
    v_mul_f32 v4, v159, v4
    s_waitcnt vmcnt(1)
    v_mul_f32 v5, -v159, v5
    s_mov_b32 s61, 65536
    s_waitcnt lgkmcnt(2)
    buffer_store_dwordx4 v[40:43], v8, s[48:51], 0 offen sc1
    s_waitcnt lgkmcnt(0)
    buffer_store_dwordx4 v[44:47], v8, s[48:51], s61 offen sc1
    v_sub_f32 v6, 0, v4
    v_mul_f32_dpp v124, v3, v25 row_newbcast:0 row_mask:0xf bank_mask:0xf
    v_mul_f32_dpp v125, v3, v25 row_newbcast:1 row_mask:0xf bank_mask:0xf
    v_mul_f32_dpp v126, v3, v25 row_newbcast:2 row_mask:0xf bank_mask:0xf
    v_mul_f32_dpp v127, v3, v25 row_newbcast:3 row_mask:0xf bank_mask:0xf
    v_mul_f32_dpp v120, v2, v25 row_newbcast:0 row_mask:0xf bank_mask:0xf
    v_mul_f32_dpp v121, v2, v25 row_newbcast:1 row_mask:0xf bank_mask:0xf
    v_mul_f32_dpp v122, v2, v25 row_newbcast:2 row_mask:0xf bank_mask:0xf
    v_mul_f32_dpp v123, v2, v25 row_newbcast:3 row_mask:0xf bank_mask:0xf
    v_fract_f32 v124, v124
    v_fract_f32 v125, v125
    v_fract_f32 v126, v126
    v_fract_f32 v127, v127
    v_exp_f32 v120, v120
    v_mul_f32_dpp v136, v3, v25 row_newbcast:4 row_mask:0xf bank_mask:0xf
    v_exp_f32 v121, v121
    v_mul_f32_dpp v137, v3, v25 row_newbcast:5 row_mask:0xf bank_mask:0xf
    v_exp_f32 v122, v122
    v_mul_f32_dpp v138, v3, v25 row_newbcast:6 row_mask:0xf bank_mask:0xf
    v_exp_f32 v123, v123
    v_mul_f32_dpp v139, v3, v25 row_newbcast:7 row_mask:0xf bank_mask:0xf
    v_sin_f32 v128, v124
    v_mul_f32_dpp v132, v2, v25 row_newbcast:4 row_mask:0xf bank_mask:0xf
    v_sin_f32 v129, v125
    v_mul_f32_dpp v133, v2, v25 row_newbcast:5 row_mask:0xf bank_mask:0xf
    v_sin_f32 v130, v126
    v_mul_f32_dpp v134, v2, v25 row_newbcast:6 row_mask:0xf bank_mask:0xf
    v_sin_f32 v131, v127
    v_mul_f32_dpp v135, v2, v25 row_newbcast:7 row_mask:0xf bank_mask:0xf
    v_cos_f32 v124, v124
    v_fract_f32 v136, v136
    v_cos_f32 v125, v125
    v_fract_f32 v137, v137
    v_cos_f32 v126, v126
    v_fract_f32 v138, v138
    v_cos_f32 v127, v127
    v_fract_f32 v139, v139
    v_exp_f32 v132, v132
    v_mul_f32 v124, v120, v124
    v_mul_f32 v125, v121, v125
    v_mul_f32 v126, v122, v126
    v_exp_f32 v133, v133
    v_mul_f32 v127, v123, v127
    v_mul_f32 v128, v120, v128
    v_mul_f32 v129, v121, v129
    v_exp_f32 v134, v134
    v_mul_f32 v130, v122, v130
    v_mul_f32 v131, v123, v131
    v_mul_f32_dpp v120, v4, v124 row_newbcast:0 row_mask:0xf bank_mask:0xf
    v_mul_f32_dpp v121, v4, v125 row_newbcast:1 row_mask:0xf bank_mask:0xf
    v_exp_f32 v135, v135
    v_mul_f32_dpp v122, v4, v126 row_newbcast:2 row_mask:0xf bank_mask:0xf
    v_mul_f32_dpp v123, v4, v127 row_newbcast:3 row_mask:0xf bank_mask:0xf
    v_mul_f32_dpp v156, v6, v128 row_newbcast:0 row_mask:0xf bank_mask:0xf
    v_sin_f32 v140, v136
    v_mul_f32_dpp v157, v6, v129 row_newbcast:1 row_mask:0xf bank_mask:0xf
    v_mul_f32_dpp v158, v6, v130 row_newbcast:2 row_mask:0xf bank_mask:0xf
    v_mul_f32_dpp v159, v6, v131 row_newbcast:3 row_mask:0xf bank_mask:0xf
    v_sin_f32 v141, v137
    v_fmac_f32_dpp v120, v5, v128 row_newbcast:0 row_mask:0xf bank_mask:0xf
    v_fmac_f32_dpp v121, v5, v129 row_newbcast:1 row_mask:0xf bank_mask:0xf
    v_fmac_f32_dpp v122, v5, v130 row_newbcast:2 row_mask:0xf bank_mask:0xf
    v_fmac_f32_dpp v123, v5, v131 row_newbcast:3 row_mask:0xf bank_mask:0xf
    v_sin_f32 v142, v138
    v_fmac_f32_dpp v156, v5, v124 row_newbcast:0 row_mask:0xf bank_mask:0xf
    v_fmac_f32_dpp v157, v5, v125 row_newbcast:1 row_mask:0xf bank_mask:0xf
    v_fmac_f32_dpp v158, v5, v126 row_newbcast:2 row_mask:0xf bank_mask:0xf
    v_sin_f32 v143, v139
    v_fmac_f32_dpp v159, v5, v127 row_newbcast:3 row_mask:0xf bank_mask:0xf
    v_cvt_pk_bf16_f32 v104, v120, v156
    v_cvt_pk_bf16_f32 v105, v121, v157
    v_cos_f32 v136, v136
    v_cvt_pk_bf16_f32 v106, v122, v158
    v_cvt_pk_bf16_f32 v107, v123, v159
    v_mul_f32_dpp v148, v3, v25 row_newbcast:8 row_mask:0xf bank_mask:0xf
    v_mul_f32_dpp v149, v3, v25 row_newbcast:9 row_mask:0xf bank_mask:0xf
    v_cos_f32 v137, v137
    v_mul_f32_dpp v150, v3, v25 row_newbcast:10 row_mask:0xf bank_mask:0xf
    v_mul_f32_dpp v151, v3, v25 row_newbcast:11 row_mask:0xf bank_mask:0xf
    v_mul_f32_dpp v144, v2, v25 row_newbcast:8 row_mask:0xf bank_mask:0xf
    v_cos_f32 v138, v138
    v_mul_f32_dpp v145, v2, v25 row_newbcast:9 row_mask:0xf bank_mask:0xf
    v_mul_f32_dpp v146, v2, v25 row_newbcast:10 row_mask:0xf bank_mask:0xf
    v_mul_f32_dpp v147, v2, v25 row_newbcast:11 row_mask:0xf bank_mask:0xf
    v_cos_f32 v139, v139
    v_fract_f32 v148, v148
    v_fract_f32 v149, v149
    v_fract_f32 v150, v150
    v_fract_f32 v151, v151
    v_exp_f32 v144, v144
    v_mul_f32 v136, v132, v136
    v_mul_f32 v137, v133, v137
    v_mul_f32 v138, v134, v138
    v_exp_f32 v145, v145
    v_mul_f32 v139, v135, v139
    v_mul_f32 v140, v132, v140
    v_mul_f32 v141, v133, v141
    v_exp_f32 v146, v146
    v_mul_f32 v142, v134, v142
    v_mul_f32 v143, v135, v143
    v_mul_f32_dpp v132, v4, v136 row_newbcast:4 row_mask:0xf bank_mask:0xf
    v_mul_f32_dpp v133, v4, v137 row_newbcast:5 row_mask:0xf bank_mask:0xf
    v_exp_f32 v147, v147
    v_mul_f32_dpp v134, v4, v138 row_newbcast:6 row_mask:0xf bank_mask:0xf
    v_mul_f32_dpp v135, v4, v139 row_newbcast:7 row_mask:0xf bank_mask:0xf
    v_mul_f32_dpp v156, v6, v140 row_newbcast:4 row_mask:0xf bank_mask:0xf
    v_sin_f32 v152, v148
    v_mul_f32_dpp v157, v6, v141 row_newbcast:5 row_mask:0xf bank_mask:0xf
    v_mul_f32_dpp v158, v6, v142 row_newbcast:6 row_mask:0xf bank_mask:0xf
    v_mul_f32_dpp v159, v6, v143 row_newbcast:7 row_mask:0xf bank_mask:0xf
    v_sin_f32 v153, v149
    v_fmac_f32_dpp v132, v5, v140 row_newbcast:4 row_mask:0xf bank_mask:0xf
    v_fmac_f32_dpp v133, v5, v141 row_newbcast:5 row_mask:0xf bank_mask:0xf
    v_fmac_f32_dpp v134, v5, v142 row_newbcast:6 row_mask:0xf bank_mask:0xf
    v_fmac_f32_dpp v135, v5, v143 row_newbcast:7 row_mask:0xf bank_mask:0xf
    v_sin_f32 v154, v150
    v_fmac_f32_dpp v156, v5, v136 row_newbcast:4 row_mask:0xf bank_mask:0xf
    v_fmac_f32_dpp v157, v5, v137 row_newbcast:5 row_mask:0xf bank_mask:0xf
    v_fmac_f32_dpp v158, v5, v138 row_newbcast:6 row_mask:0xf bank_mask:0xf
    v_sin_f32 v155, v151
    v_fmac_f32_dpp v159, v5, v139 row_newbcast:7 row_mask:0xf bank_mask:0xf
    v_cvt_pk_bf16_f32 v108, v132, v156
    v_cvt_pk_bf16_f32 v109, v133, v157
    v_cos_f32 v148, v148
    v_cvt_pk_bf16_f32 v110, v134, v158
    v_cvt_pk_bf16_f32 v111, v135, v159
    v_mul_f32_dpp v124, v3, v25 row_newbcast:12 row_mask:0xf bank_mask:0xf
    v_mul_f32_dpp v125, v3, v25 row_newbcast:13 row_mask:0xf bank_mask:0xf
    v_cos_f32 v149, v149
    v_mul_f32_dpp v126, v3, v25 row_newbcast:14 row_mask:0xf bank_mask:0xf
    v_mul_f32_dpp v127, v3, v25 row_newbcast:15 row_mask:0xf bank_mask:0xf
    v_mul_f32_dpp v120, v2, v25 row_newbcast:12 row_mask:0xf bank_mask:0xf
    v_cos_f32 v150, v150
    v_mul_f32_dpp v121, v2, v25 row_newbcast:13 row_mask:0xf bank_mask:0xf
    v_mov_b32 v17, s60
    s_mov_b64 exec, 1
    s_waitcnt vmcnt(0)
    buffer_store_dword v17, v9, s[48:51], 0 offen sc1
    s_mov_b64 exec, -1
    ds_write_b32 v14, v16 offset:112
    v_mul_f32_dpp v122, v2, v25 row_newbcast:14 row_mask:0xf bank_mask:0xf
    v_mul_f32_dpp v123, v2, v25 row_newbcast:15 row_mask:0xf bank_mask:0xf
    v_cos_f32 v151, v151
    v_fract_f32 v124, v124
    v_fract_f32 v125, v125
    v_fract_f32 v126, v126
    v_fract_f32 v127, v127
    v_exp_f32 v120, v120
    v_mul_f32 v148, v144, v148
    v_mul_f32 v149, v145, v149
    v_mul_f32 v150, v146, v150
    v_exp_f32 v121, v121
    v_mul_f32 v151, v147, v151
    v_mul_f32 v152, v144, v152
    v_mul_f32 v153, v145, v153
    v_exp_f32 v122, v122
    v_mul_f32 v154, v146, v154
    v_mul_f32 v155, v147, v155
    v_mul_f32_dpp v144, v4, v148 row_newbcast:8 row_mask:0xf bank_mask:0xf
    v_mul_f32_dpp v145, v4, v149 row_newbcast:9 row_mask:0xf bank_mask:0xf
    v_exp_f32 v123, v123
    v_mul_f32_dpp v146, v4, v150 row_newbcast:10 row_mask:0xf bank_mask:0xf
    v_mul_f32_dpp v147, v4, v151 row_newbcast:11 row_mask:0xf bank_mask:0xf
    v_mul_f32_dpp v156, v6, v152 row_newbcast:8 row_mask:0xf bank_mask:0xf
    v_sin_f32 v128, v124
    v_mul_f32_dpp v157, v6, v153 row_newbcast:9 row_mask:0xf bank_mask:0xf
    v_mul_f32_dpp v158, v6, v154 row_newbcast:10 row_mask:0xf bank_mask:0xf
    v_mul_f32_dpp v159, v6, v155 row_newbcast:11 row_mask:0xf bank_mask:0xf
    v_sin_f32 v129, v125
    v_fmac_f32_dpp v144, v5, v152 row_newbcast:8 row_mask:0xf bank_mask:0xf
    v_fmac_f32_dpp v145, v5, v153 row_newbcast:9 row_mask:0xf bank_mask:0xf
    v_fmac_f32_dpp v146, v5, v154 row_newbcast:10 row_mask:0xf bank_mask:0xf
    v_fmac_f32_dpp v147, v5, v155 row_newbcast:11 row_mask:0xf bank_mask:0xf
    v_sin_f32 v130, v126
    v_fmac_f32_dpp v156, v5, v148 row_newbcast:8 row_mask:0xf bank_mask:0xf
    v_fmac_f32_dpp v157, v5, v149 row_newbcast:9 row_mask:0xf bank_mask:0xf
    v_fmac_f32_dpp v158, v5, v150 row_newbcast:10 row_mask:0xf bank_mask:0xf
    v_sin_f32 v131, v127
    v_fmac_f32_dpp v159, v5, v151 row_newbcast:11 row_mask:0xf bank_mask:0xf
    v_cvt_pk_bf16_f32 v112, v144, v156
    v_cvt_pk_bf16_f32 v113, v145, v157
    v_cos_f32 v124, v124
    v_cvt_pk_bf16_f32 v114, v146, v158
    v_cvt_pk_bf16_f32 v115, v147, v159
    v_mul_f32_dpp v136, v3, v22 row_newbcast:0 row_mask:0xf bank_mask:0xf
    v_mul_f32_dpp v137, v3, v22 row_newbcast:1 row_mask:0xf bank_mask:0xf
    v_cos_f32 v125, v125
    v_mul_f32_dpp v138, v3, v22 row_newbcast:2 row_mask:0xf bank_mask:0xf
    v_mul_f32_dpp v139, v3, v22 row_newbcast:3 row_mask:0xf bank_mask:0xf
    v_mul_f32_dpp v132, v2, v22 row_newbcast:0 row_mask:0xf bank_mask:0xf
    v_cos_f32 v126, v126
    v_mul_f32_dpp v133, v2, v22 row_newbcast:1 row_mask:0xf bank_mask:0xf
    v_mul_f32_dpp v134, v2, v22 row_newbcast:2 row_mask:0xf bank_mask:0xf
    v_mul_f32_dpp v135, v2, v22 row_newbcast:3 row_mask:0xf bank_mask:0xf
    v_cos_f32 v127, v127
    v_fract_f32 v136, v136
    v_fract_f32 v137, v137
    v_fract_f32 v138, v138
    v_fract_f32 v139, v139
    v_exp_f32 v132, v132
    v_mul_f32 v124, v120, v124
    v_mul_f32 v125, v121, v125
    v_mul_f32 v126, v122, v126
    v_exp_f32 v133, v133
    v_mul_f32 v127, v123, v127
    v_mul_f32 v128, v120, v128
    v_mul_f32 v129, v121, v129
    v_exp_f32 v134, v134
    v_mul_f32 v130, v122, v130
    v_mul_f32 v131, v123, v131
    v_mul_f32_dpp v120, v4, v124 row_newbcast:12 row_mask:0xf bank_mask:0xf
    v_mul_f32_dpp v121, v4, v125 row_newbcast:13 row_mask:0xf bank_mask:0xf
    v_exp_f32 v135, v135
    v_mul_f32_dpp v122, v4, v126 row_newbcast:14 row_mask:0xf bank_mask:0xf
    v_mul_f32_dpp v123, v4, v127 row_newbcast:15 row_mask:0xf bank_mask:0xf
    v_mul_f32_dpp v156, v6, v128 row_newbcast:12 row_mask:0xf bank_mask:0xf
    v_sin_f32 v140, v136
    v_mul_f32_dpp v157, v6, v129 row_newbcast:13 row_mask:0xf bank_mask:0xf
    v_mul_f32_dpp v158, v6, v130 row_newbcast:14 row_mask:0xf bank_mask:0xf
    v_mul_f32_dpp v159, v6, v131 row_newbcast:15 row_mask:0xf bank_mask:0xf
    v_sin_f32 v141, v137
    v_fmac_f32_dpp v120, v5, v128 row_newbcast:12 row_mask:0xf bank_mask:0xf
    v_fmac_f32_dpp v121, v5, v129 row_newbcast:13 row_mask:0xf bank_mask:0xf
    v_fmac_f32_dpp v122, v5, v130 row_newbcast:14 row_mask:0xf bank_mask:0xf
    v_fmac_f32_dpp v123, v5, v131 row_newbcast:15 row_mask:0xf bank_mask:0xf
    v_sin_f32 v142, v138
    v_fmac_f32_dpp v156, v5, v124 row_newbcast:12 row_mask:0xf bank_mask:0xf
    v_fmac_f32_dpp v157, v5, v125 row_newbcast:13 row_mask:0xf bank_mask:0xf
    v_fmac_f32_dpp v158, v5, v126 row_newbcast:14 row_mask:0xf bank_mask:0xf
    v_sin_f32 v143, v139
    v_fmac_f32_dpp v159, v5, v127 row_newbcast:15 row_mask:0xf bank_mask:0xf
    v_cvt_pk_bf16_f32 v116, v120, v156
    v_cvt_pk_bf16_f32 v117, v121, v157
    v_cos_f32 v136, v136
    v_cvt_pk_bf16_f32 v118, v122, v158
    v_cvt_pk_bf16_f32 v119, v123, v159
    v_mul_f32_dpp v148, v3, v22 row_newbcast:4 row_mask:0xf bank_mask:0xf
    v_mul_f32_dpp v149, v3, v22 row_newbcast:5 row_mask:0xf bank_mask:0xf
    v_cos_f32 v137, v137
    v_mul_f32_dpp v150, v3, v22 row_newbcast:6 row_mask:0xf bank_mask:0xf
    v_mul_f32_dpp v151, v3, v22 row_newbcast:7 row_mask:0xf bank_mask:0xf
    v_mul_f32_dpp v144, v2, v22 row_newbcast:4 row_mask:0xf bank_mask:0xf
    v_cos_f32 v138, v138
    v_mul_f32_dpp v145, v2, v22 row_newbcast:5 row_mask:0xf bank_mask:0xf
    v_mul_f32_dpp v146, v2, v22 row_newbcast:6 row_mask:0xf bank_mask:0xf
    v_mul_f32_dpp v147, v2, v22 row_newbcast:7 row_mask:0xf bank_mask:0xf
    v_cos_f32 v139, v139
    v_fract_f32 v148, v148
    v_fract_f32 v149, v149
    v_fract_f32 v150, v150
    v_fract_f32 v151, v151
    v_exp_f32 v144, v144
    v_mul_f32 v136, v132, v136
    v_mul_f32 v137, v133, v137
    v_exp_f32 v145, v145
    v_mul_f32 v138, v134, v138
    v_mul_f32 v139, v135, v139
    v_exp_f32 v146, v146
    v_mul_f32 v140, v132, v140
    v_mul_f32 v141, v133, v141
    v_exp_f32 v147, v147
    v_mul_f32 v142, v134, v142
    v_mul_f32 v143, v135, v143
    v_sin_f32 v152, v148
    v_cvt_pk_bf16_f32 v72, v136, v140
    v_cvt_pk_bf16_f32 v73, v137, v141
    v_sin_f32 v153, v149
    v_cvt_pk_bf16_f32 v74, v138, v142
    v_cvt_pk_bf16_f32 v75, v139, v143
    v_sin_f32 v154, v150
    v_mul_f32_dpp v124, v3, v22 row_newbcast:8 row_mask:0xf bank_mask:0xf
    v_mul_f32_dpp v125, v3, v22 row_newbcast:9 row_mask:0xf bank_mask:0xf
    v_sin_f32 v155, v151
    v_mul_f32_dpp v126, v3, v22 row_newbcast:10 row_mask:0xf bank_mask:0xf
    v_mul_f32_dpp v127, v3, v22 row_newbcast:11 row_mask:0xf bank_mask:0xf
    v_cos_f32 v148, v148
    v_mul_f32_dpp v120, v2, v22 row_newbcast:8 row_mask:0xf bank_mask:0xf
    v_mul_f32_dpp v121, v2, v22 row_newbcast:9 row_mask:0xf bank_mask:0xf
    v_cos_f32 v149, v149
    v_mul_f32_dpp v122, v2, v22 row_newbcast:10 row_mask:0xf bank_mask:0xf
    v_mul_f32_dpp v123, v2, v22 row_newbcast:11 row_mask:0xf bank_mask:0xf
    v_cos_f32 v150, v150
    v_fract_f32 v124, v124
    v_fract_f32 v125, v125
    v_cos_f32 v151, v151
    v_fract_f32 v126, v126
    v_fract_f32 v127, v127
    v_exp_f32 v120, v120
    v_mfma_f32_16x16x32_bf16 a[0:3], v[72:75], v[104:107], 0
    v_mul_f32 v148, v144, v148
    v_exp_f32 v121, v121
    v_mul_f32 v149, v145, v149
    v_mul_f32 v150, v146, v150
    v_mul_f32 v151, v147, v151
    v_exp_f32 v122, v122
    v_mul_f32 v152, v144, v152
    v_mul_f32 v153, v145, v153
    v_exp_f32 v123, v123
    v_mul_f32 v154, v146, v154
    v_mul_f32 v155, v147, v155
    v_cvt_pk_bf16_f32 v76, v148, v152
    v_sin_f32 v128, v124
    v_cvt_pk_bf16_f32 v77, v149, v153
    v_cvt_pk_bf16_f32 v78, v150, v154
    v_sin_f32 v129, v125
    v_cvt_pk_bf16_f32 v79, v151, v155
    v_mul_f32_dpp v136, v3, v22 row_newbcast:12 row_mask:0xf bank_mask:0xf
    v_mul_f32_dpp v137, v3, v22 row_newbcast:13 row_mask:0xf bank_mask:0xf
    v_sin_f32 v130, v126
    v_mul_f32_dpp v138, v3, v22 row_newbcast:14 row_mask:0xf bank_mask:0xf
    v_mul_f32_dpp v139, v3, v22 row_newbcast:15 row_mask:0xf bank_mask:0xf
    v_sin_f32 v131, v127
    v_mul_f32_dpp v132, v2, v22 row_newbcast:12 row_mask:0xf bank_mask:0xf
    v_mul_f32_dpp v133, v2, v22 row_newbcast:13 row_mask:0xf bank_mask:0xf
    v_mul_f32_dpp v134, v2, v22 row_newbcast:14 row_mask:0xf bank_mask:0xf
    v_cos_f32 v124, v124
    v_mul_f32_dpp v135, v2, v22 row_newbcast:15 row_mask:0xf bank_mask:0xf
    v_fract_f32 v136, v136
    v_cos_f32 v125, v125
    v_fract_f32 v137, v137
    v_fract_f32 v138, v138
    v_fract_f32 v139, v139
    v_cos_f32 v126, v126
    v_add_f32 v157, 0xbf800000, v69
    v_cvt_pk_bf16_f32 v156, v69, v157
    v_cos_f32 v127, v127
    v_mad_u32_u16 v88, v156, 4, v68
    v_mad_u32_u16 v89, v156, 4, v68 op_sel:[1,0,0,0]
    v_add_f32 v158, 0xc0000000, v69
    v_exp_f32 v132, v132
    v_mfma_f32_16x16x32_bf16 a[0:3], v[76:79], v[108:111], a[0:3]
    v_mul_f32 v124, v120, v124
    v_exp_f32 v133, v133
    v_mul_f32 v125, v121, v125
    v_mul_f32 v126, v122, v126
    v_mul_f32 v127, v123, v127
    v_exp_f32 v134, v134
    v_mul_f32 v128, v120, v128
    v_mul_f32 v129, v121, v129
    v_exp_f32 v135, v135
    v_mul_f32 v130, v122, v130
    v_mul_f32 v131, v123, v131
    v_cvt_pk_bf16_f32 v80, v124, v128
    v_sin_f32 v140, v136
    v_cvt_pk_bf16_f32 v81, v125, v129
    v_cvt_pk_bf16_f32 v82, v126, v130
    v_sin_f32 v141, v137
    v_cvt_pk_bf16_f32 v83, v127, v131
    v_mul_f32_dpp v148, v3, v23 row_newbcast:0 row_mask:0xf bank_mask:0xf
    v_mul_f32_dpp v149, v3, v23 row_newbcast:1 row_mask:0xf bank_mask:0xf
    v_sin_f32 v142, v138
    v_mul_f32_dpp v150, v3, v23 row_newbcast:2 row_mask:0xf bank_mask:0xf
    v_mul_f32_dpp v151, v3, v23 row_newbcast:3 row_mask:0xf bank_mask:0xf
    v_sin_f32 v143, v139
    v_mul_f32_dpp v144, v2, v23 row_newbcast:0 row_mask:0xf bank_mask:0xf
    v_mul_f32_dpp v145, v2, v23 row_newbcast:1 row_mask:0xf bank_mask:0xf
    v_mul_f32_dpp v146, v2, v23 row_newbcast:2 row_mask:0xf bank_mask:0xf
    v_cos_f32 v136, v136
    v_mul_f32_dpp v147, v2, v23 row_newbcast:3 row_mask:0xf bank_mask:0xf
    v_fract_f32 v148, v148
    v_cos_f32 v137, v137
    v_fract_f32 v149, v149
    v_fract_f32 v150, v150
    v_fract_f32 v151, v151
    v_cos_f32 v138, v138
    v_add_f32 v159, 0xc0400000, v69
    v_cvt_pk_bf16_f32 v158, v158, v159
    v_cos_f32 v139, v139
    v_mad_u32_u16 v90, v158, 4, v68
    v_mad_u32_u16 v91, v158, 4, v68 op_sel:[1,0,0,0]
    v_add_f32 v156, 0xc0800000, v69
    v_exp_f32 v144, v144
    v_mfma_f32_16x16x32_bf16 a[0:3], v[80:83], v[112:115], a[0:3]
    v_mul_f32 v136, v132, v136
    v_exp_f32 v145, v145
    v_mul_f32 v137, v133, v137
    v_mul_f32 v138, v134, v138
    v_mul_f32 v139, v135, v139
    v_exp_f32 v146, v146
    v_mul_f32 v140, v132, v140
    v_mul_f32 v141, v133, v141
    v_exp_f32 v147, v147
    v_mul_f32 v142, v134, v142
    v_mul_f32 v143, v135, v143
    v_cvt_pk_bf16_f32 v84, v136, v140
    v_sin_f32 v152, v148
    v_cvt_pk_bf16_f32 v85, v137, v141
    v_cvt_pk_bf16_f32 v86, v138, v142
    v_sin_f32 v153, v149
    v_cvt_pk_bf16_f32 v87, v139, v143
    v_mul_f32_dpp v124, v3, v23 row_newbcast:4 row_mask:0xf bank_mask:0xf
    v_mul_f32_dpp v125, v3, v23 row_newbcast:5 row_mask:0xf bank_mask:0xf
    v_sin_f32 v154, v150
    v_mul_f32_dpp v126, v3, v23 row_newbcast:6 row_mask:0xf bank_mask:0xf
    v_mul_f32_dpp v127, v3, v23 row_newbcast:7 row_mask:0xf bank_mask:0xf
    v_sin_f32 v155, v151
    v_mul_f32_dpp v120, v2, v23 row_newbcast:4 row_mask:0xf bank_mask:0xf
    v_mul_f32_dpp v121, v2, v23 row_newbcast:5 row_mask:0xf bank_mask:0xf
    v_mul_f32_dpp v122, v2, v23 row_newbcast:6 row_mask:0xf bank_mask:0xf
    v_cos_f32 v148, v148
    v_mul_f32_dpp v123, v2, v23 row_newbcast:7 row_mask:0xf bank_mask:0xf
    v_fract_f32 v124, v124
    v_cos_f32 v149, v149
    v_fract_f32 v125, v125
    v_fract_f32 v126, v126
    v_fract_f32 v127, v127
    v_cos_f32 v150, v150
    v_add_f32 v157, 0xc0a00000, v69
    v_cvt_pk_bf16_f32 v156, v156, v157
    v_cos_f32 v151, v151
    v_mad_u32_u16 v92, v156, 4, v68
    v_mad_u32_u16 v93, v156, 4, v68 op_sel:[1,0,0,0]
    v_add_f32 v158, 0xc0c00000, v69
    v_exp_f32 v120, v120
    v_mfma_f32_16x16x32_bf16 a[0:3], v[84:87], v[116:119], a[0:3]
    v_mul_f32 v148, v144, v148
    v_exp_f32 v121, v121
    v_mul_f32 v149, v145, v149
    v_mul_f32 v150, v146, v150
    v_mul_f32 v151, v147, v151
    v_exp_f32 v122, v122
    v_mul_f32 v152, v144, v152
    v_mul_f32 v153, v145, v153
    v_exp_f32 v123, v123
    v_mul_f32 v154, v146, v154
    v_mul_f32 v155, v147, v155
    v_cvt_pk_bf16_f32 v72, v148, v152
    v_sin_f32 v128, v124
    v_cvt_pk_bf16_f32 v73, v149, v153
    v_cvt_pk_bf16_f32 v74, v150, v154
    v_sin_f32 v129, v125
    v_cvt_pk_bf16_f32 v75, v151, v155
    v_mul_f32_dpp v136, v3, v23 row_newbcast:8 row_mask:0xf bank_mask:0xf
    v_mul_f32_dpp v137, v3, v23 row_newbcast:9 row_mask:0xf bank_mask:0xf
    v_sin_f32 v130, v126
    v_mul_f32_dpp v138, v3, v23 row_newbcast:10 row_mask:0xf bank_mask:0xf
    v_mul_f32_dpp v139, v3, v23 row_newbcast:11 row_mask:0xf bank_mask:0xf
    v_sin_f32 v131, v127
    v_mul_f32_dpp v132, v2, v23 row_newbcast:8 row_mask:0xf bank_mask:0xf
    v_mul_f32_dpp v133, v2, v23 row_newbcast:9 row_mask:0xf bank_mask:0xf
    v_mul_f32_dpp v134, v2, v23 row_newbcast:10 row_mask:0xf bank_mask:0xf
    v_cos_f32 v124, v124
    v_mul_f32_dpp v135, v2, v23 row_newbcast:11 row_mask:0xf bank_mask:0xf
    v_fract_f32 v136, v136
    v_cos_f32 v125, v125
    v_fract_f32 v137, v137
    v_fract_f32 v138, v138
    v_fract_f32 v139, v139
    v_cos_f32 v126, v126
    v_add_f32 v159, 0xc0e00000, v69
    v_cvt_pk_bf16_f32 v158, v158, v159
    v_cos_f32 v127, v127
    v_mad_u32_u16 v94, v158, 4, v68
    v_mad_u32_u16 v95, v158, 4, v68 op_sel:[1,0,0,0]
    v_add_f32 v156, 0xc1000000, v69
    v_exp_f32 v132, v132
    v_mfma_f32_16x16x32_bf16 a[4:7], v[72:75], v[104:107], 0
    v_mul_f32 v124, v120, v124
    v_exp_f32 v133, v133
    v_mul_f32 v125, v121, v125
    v_mul_f32 v126, v122, v126
    v_mul_f32 v127, v123, v127
    v_exp_f32 v134, v134
    v_mul_f32 v128, v120, v128
    v_mul_f32 v129, v121, v129
    v_exp_f32 v135, v135
    v_mul_f32 v130, v122, v130
    v_mul_f32 v131, v123, v131
    v_cvt_pk_bf16_f32 v76, v124, v128
    v_sin_f32 v140, v136
    v_cvt_pk_bf16_f32 v77, v125, v129
    v_cvt_pk_bf16_f32 v78, v126, v130
    v_sin_f32 v141, v137
    v_cvt_pk_bf16_f32 v79, v127, v131
    v_mul_f32_dpp v148, v3, v23 row_newbcast:12 row_mask:0xf bank_mask:0xf
    v_mul_f32_dpp v149, v3, v23 row_newbcast:13 row_mask:0xf bank_mask:0xf
    v_sin_f32 v142, v138
    v_mul_f32_dpp v150, v3, v23 row_newbcast:14 row_mask:0xf bank_mask:0xf
    v_mul_f32_dpp v151, v3, v23 row_newbcast:15 row_mask:0xf bank_mask:0xf
    v_mul_f32_dpp v144, v2, v23 row_newbcast:12 row_mask:0xf bank_mask:0xf
    v_sin_f32 v143, v139
    v_mul_f32_dpp v145, v2, v23 row_newbcast:13 row_mask:0xf bank_mask:0xf
    v_mul_f32_dpp v146, v2, v23 row_newbcast:14 row_mask:0xf bank_mask:0xf
    v_cos_f32 v136, v136
    v_mul_f32_dpp v147, v2, v23 row_newbcast:15 row_mask:0xf bank_mask:0xf
    v_fract_f32 v148, v148
    v_fract_f32 v149, v149
    v_cos_f32 v137, v137
    v_fract_f32 v150, v150
    v_fract_f32 v151, v151
    v_cos_f32 v138, v138
    ds_write_b128 v18, a[0:3]
    v_add_f32 v157, 0xc1100000, v69
    v_cvt_pk_bf16_f32 v156, v156, v157
    v_cos_f32 v139, v139
    v_mad_u32_u16 v96, v156, 4, v68
    v_mad_u32_u16 v97, v156, 4, v68 op_sel:[1,0,0,0]
    v_add_f32 v158, 0xc1200000, v69
    v_exp_f32 v144, v144
    v_mfma_f32_16x16x32_bf16 a[4:7], v[76:79], v[108:111], a[4:7]
    v_mul_f32 v136, v132, v136
    v_exp_f32 v145, v145
    v_mul_f32 v137, v133, v137
    v_mul_f32 v138, v134, v138
    v_mul_f32 v139, v135, v139
    v_exp_f32 v146, v146
    v_mul_f32 v140, v132, v140
    v_mul_f32 v141, v133, v141
    v_exp_f32 v147, v147
    v_mul_f32 v142, v134, v142
    v_mul_f32 v143, v135, v143
    v_cvt_pk_bf16_f32 v80, v136, v140
    v_sin_f32 v152, v148
    v_cvt_pk_bf16_f32 v81, v137, v141
    v_cvt_pk_bf16_f32 v82, v138, v142
    v_sin_f32 v153, v149
    v_cvt_pk_bf16_f32 v83, v139, v143
    v_mul_f32_dpp v124, v3, v24 row_newbcast:0 row_mask:0xf bank_mask:0xf
    v_mul_f32_dpp v125, v3, v24 row_newbcast:1 row_mask:0xf bank_mask:0xf
    v_sin_f32 v154, v150
    v_mul_f32_dpp v126, v3, v24 row_newbcast:2 row_mask:0xf bank_mask:0xf
    v_mul_f32_dpp v127, v3, v24 row_newbcast:3 row_mask:0xf bank_mask:0xf
    v_sin_f32 v155, v151
    v_mul_f32_dpp v120, v2, v24 row_newbcast:0 row_mask:0xf bank_mask:0xf
    v_mul_f32_dpp v121, v2, v24 row_newbcast:1 row_mask:0xf bank_mask:0xf
    v_mul_f32_dpp v122, v2, v24 row_newbcast:2 row_mask:0xf bank_mask:0xf
    v_cos_f32 v148, v148
    v_mul_f32_dpp v123, v2, v24 row_newbcast:3 row_mask:0xf bank_mask:0xf
    v_fract_f32 v124, v124
    v_cos_f32 v149, v149
    v_fract_f32 v125, v125
    v_fract_f32 v126, v126
    v_fract_f32 v127, v127
    v_cos_f32 v150, v150
    v_add_f32 v159, 0xc1300000, v69
    v_cvt_pk_bf16_f32 v158, v158, v159
    v_cos_f32 v151, v151
    v_mad_u32_u16 v98, v158, 4, v68
    v_mad_u32_u16 v99, v158, 4, v68 op_sel:[1,0,0,0]
    v_add_f32 v156, 0xc1400000, v69
    v_exp_f32 v120, v120
    v_mfma_f32_16x16x32_bf16 a[4:7], v[80:83], v[112:115], a[4:7]
    v_mul_f32 v148, v144, v148
    v_exp_f32 v121, v121
    v_mul_f32 v149, v145, v149
    v_mul_f32 v150, v146, v150
    v_mul_f32 v151, v147, v151
    v_exp_f32 v122, v122
    v_mul_f32 v152, v144, v152
    v_mul_f32 v153, v145, v153
    v_exp_f32 v123, v123
    v_mul_f32 v154, v146, v154
    v_mul_f32 v155, v147, v155
    v_cvt_pk_bf16_f32 v84, v148, v152
    v_sin_f32 v128, v124
    v_cvt_pk_bf16_f32 v85, v149, v153
    v_cvt_pk_bf16_f32 v86, v150, v154
    v_sin_f32 v129, v125
    v_cvt_pk_bf16_f32 v87, v151, v155
    v_mul_f32_dpp v136, v3, v24 row_newbcast:4 row_mask:0xf bank_mask:0xf
    v_mul_f32_dpp v137, v3, v24 row_newbcast:5 row_mask:0xf bank_mask:0xf
    v_sin_f32 v130, v126
    v_mul_f32_dpp v138, v3, v24 row_newbcast:6 row_mask:0xf bank_mask:0xf
    v_mul_f32_dpp v139, v3, v24 row_newbcast:7 row_mask:0xf bank_mask:0xf
    v_sin_f32 v131, v127
    v_mul_f32_dpp v132, v2, v24 row_newbcast:4 row_mask:0xf bank_mask:0xf
    v_mul_f32_dpp v133, v2, v24 row_newbcast:5 row_mask:0xf bank_mask:0xf
    v_mul_f32_dpp v134, v2, v24 row_newbcast:6 row_mask:0xf bank_mask:0xf
    v_cos_f32 v124, v124
    v_mul_f32_dpp v135, v2, v24 row_newbcast:7 row_mask:0xf bank_mask:0xf
    v_fract_f32 v136, v136
    v_cos_f32 v125, v125
    v_fract_f32 v137, v137
    v_fract_f32 v138, v138
    v_fract_f32 v139, v139
    v_cos_f32 v126, v126
    v_add_f32 v157, 0xc1500000, v69
    v_cvt_pk_bf16_f32 v156, v156, v157
    v_cos_f32 v127, v127
    v_mad_u32_u16 v100, v156, 4, v68
    v_mad_u32_u16 v101, v156, 4, v68 op_sel:[1,0,0,0]
    v_add_f32 v158, 0xc1600000, v69
    v_exp_f32 v132, v132
    v_mfma_f32_16x16x32_bf16 a[4:7], v[84:87], v[116:119], a[4:7]
    v_mul_f32 v124, v120, v124
    v_exp_f32 v133, v133
    v_mul_f32 v125, v121, v125
    v_mul_f32 v126, v122, v126
    v_mul_f32 v127, v123, v127
    v_exp_f32 v134, v134
    v_mul_f32 v128, v120, v128
    v_mul_f32 v129, v121, v129
    v_exp_f32 v135, v135
    v_mul_f32 v130, v122, v130
    v_mul_f32 v131, v123, v131
    v_cvt_pk_bf16_f32 v72, v124, v128
    v_sin_f32 v140, v136
    v_cvt_pk_bf16_f32 v73, v125, v129
    v_cvt_pk_bf16_f32 v74, v126, v130
    v_sin_f32 v141, v137
    v_cvt_pk_bf16_f32 v75, v127, v131
    v_mul_f32_dpp v148, v3, v24 row_newbcast:8 row_mask:0xf bank_mask:0xf
    v_mul_f32_dpp v149, v3, v24 row_newbcast:9 row_mask:0xf bank_mask:0xf
    v_sin_f32 v142, v138
    v_mul_f32_dpp v150, v3, v24 row_newbcast:10 row_mask:0xf bank_mask:0xf
    v_mul_f32_dpp v151, v3, v24 row_newbcast:11 row_mask:0xf bank_mask:0xf
    v_sin_f32 v143, v139
    v_mul_f32_dpp v144, v2, v24 row_newbcast:8 row_mask:0xf bank_mask:0xf
    v_mul_f32_dpp v145, v2, v24 row_newbcast:9 row_mask:0xf bank_mask:0xf
    v_mul_f32_dpp v146, v2, v24 row_newbcast:10 row_mask:0xf bank_mask:0xf
    v_cos_f32 v136, v136
    v_mul_f32_dpp v147, v2, v24 row_newbcast:11 row_mask:0xf bank_mask:0xf
    v_fract_f32 v148, v148
    v_cos_f32 v137, v137
    v_fract_f32 v149, v149
    v_fract_f32 v150, v150
    v_fract_f32 v151, v151
    v_cos_f32 v138, v138
    v_add_f32 v159, 0xc1700000, v69
    v_cvt_pk_bf16_f32 v158, v158, v159
    v_cos_f32 v139, v139
    v_mad_u32_u16 v102, v158, 4, v68
    v_mad_u32_u16 v103, v158, 4, v68 op_sel:[1,0,0,0]
    v_writelane_b32 v88, s73, 0
    v_exp_f32 v144, v144
    v_mfma_f32_16x16x32_bf16 a[8:11], v[72:75], v[104:107], 0
    v_mul_f32 v136, v132, v136
    v_exp_f32 v145, v145
    v_mul_f32 v137, v133, v137
    v_mul_f32 v138, v134, v138
    v_exp_f32 v146, v146
    v_mul_f32 v139, v135, v139
    v_mul_f32 v140, v132, v140
    v_mul_f32 v141, v133, v141
    v_exp_f32 v147, v147
    v_mul_f32 v142, v134, v142
    v_mul_f32 v143, v135, v143
    v_sin_f32 v152, v148
    v_cvt_pk_bf16_f32 v76, v136, v140
    v_cvt_pk_bf16_f32 v77, v137, v141
    v_sin_f32 v153, v149
    v_cvt_pk_bf16_f32 v78, v138, v142
    v_cvt_pk_bf16_f32 v79, v139, v143
    v_mul_f32_dpp v124, v3, v24 row_newbcast:12 row_mask:0xf bank_mask:0xf
    v_sin_f32 v154, v150
    v_mul_f32_dpp v125, v3, v24 row_newbcast:13 row_mask:0xf bank_mask:0xf
    v_mul_f32_dpp v126, v3, v24 row_newbcast:14 row_mask:0xf bank_mask:0xf
    v_sin_f32 v155, v151
    v_mul_f32_dpp v127, v3, v24 row_newbcast:15 row_mask:0xf bank_mask:0xf
    v_mul_f32_dpp v120, v2, v24 row_newbcast:12 row_mask:0xf bank_mask:0xf
    v_cos_f32 v148, v148
    v_mul_f32_dpp v121, v2, v24 row_newbcast:13 row_mask:0xf bank_mask:0xf
    v_mul_f32_dpp v122, v2, v24 row_newbcast:14 row_mask:0xf bank_mask:0xf
    v_mul_f32_dpp v123, v2, v24 row_newbcast:15 row_mask:0xf bank_mask:0xf
    v_cos_f32 v149, v149
    v_fract_f32 v124, v124
    v_fract_f32 v125, v125
    v_cos_f32 v150, v150
    v_fract_f32 v126, v126
    v_fract_f32 v127, v127
    v_cos_f32 v151, v151
    ds_write_b64 v19, a[4:5]
    ds_write_b64 v20, a[6:7]
    v_writelane_b32 v89, s73, 0
    v_exp_f32 v120, v120
    v_mfma_f32_16x16x32_bf16 a[8:11], v[76:79], v[108:111], a[8:11]
    v_exp_f32 v121, v121
    v_mul_f32 v148, v144, v148
    v_exp_f32 v122, v122
    v_mul_f32 v149, v145, v149
    v_exp_f32 v123, v123
    v_mul_f32 v150, v146, v150
    v_sin_f32 v128, v124
    v_mul_f32 v151, v147, v151
    v_sin_f32 v129, v125
    v_mul_f32 v152, v144, v152
    v_sin_f32 v130, v126
    v_mul_f32 v153, v145, v153
    v_sin_f32 v131, v127
    v_mul_f32 v154, v146, v154
    v_cos_f32 v124, v124
    v_mul_f32 v155, v147, v155
    v_cos_f32 v125, v125
    v_cvt_pk_bf16_f32 v80, v148, v152
    v_cos_f32 v126, v126
    v_cvt_pk_bf16_f32 v81, v149, v153
    v_cos_f32 v127, v127
    v_cvt_pk_bf16_f32 v82, v150, v154
    v_cvt_pk_bf16_f32 v83, v151, v155
    s_nop 1
    v_mfma_f32_16x16x32_bf16 a[8:11], v[80:83], v[112:115], a[8:11]
    v_mul_f32 v124, v120, v124
    v_mul_f32 v125, v121, v125
    v_mul_f32 v126, v122, v126
    v_mul_f32 v127, v123, v127
    v_mul_f32 v128, v120, v128
    v_mul_f32 v129, v121, v129
    v_mul_f32 v130, v122, v130
    v_mul_f32 v131, v123, v131
    v_cvt_pk_bf16_f32 v84, v124, v128
    v_cvt_pk_bf16_f32 v85, v125, v129
    v_cvt_pk_bf16_f32 v86, v126, v130
    v_cvt_pk_bf16_f32 v87, v127, v131
    s_nop 1
    v_mfma_f32_16x16x32_bf16 a[8:11], v[84:87], v[116:119], a[8:11]
    s_nop 7
    ds_write_b32 v21, a8 offset:0
    ds_write_b32 v21, a9 offset:64
    ds_write_b32 v21, a10 offset:128
    ds_write_b32 v21, a11 offset:192
    ds_write_b32 v14, v16 offset:0
    ds_read_b32 v17, v15 offset:0
    ds_read_b32 v71, v13 offset:80
    s_waitcnt lgkmcnt(0)
    v_cmp_gt_u32 vcc, 5, v71
    s_nop 0
    s_cbranch_vccnz Lvp61
Lvk62:
    buffer_load_dword v37, v36, s[48:51], 0 offen sc1
    v_readfirstlane_b32 s61, v17
    s_nop 0
    s_cmp_lt_u32 s61, 1
    s_cbranch_scc1 Lsp67
Lok68:
    ds_read_b32 v72, v88
    ds_read_b32 v120, v88 offset:4160
    ds_read_b32 v73, v89
    ds_read_b32 v121, v89 offset:4160
    ds_read_b32 v74, v90
    ds_read_b32 v122, v90 offset:4160
    ds_read_b32 v75, v91
    ds_read_b32 v123, v91 offset:4160
    ds_read_b32 v76, v92
    ds_read_b32 v124, v92 offset:4160
    ds_read_b32 v77, v93
    ds_read_b32 v125, v93 offset:4160
    ds_read_b32 v78, v94
    ds_read_b32 v126, v94 offset:4160
    ds_read_b32 v79, v95
    ds_read_b32 v127, v95 offset:4160
    ds_read_b32 v80, v96
    ds_read_b32 v128, v96 offset:4160
    ds_read_b32 v81, v97
    ds_read_b32 v129, v97 offset:4160
    ds_read_b32 v82, v98
    ds_read_b32 v130, v98 offset:4160
    ds_read_b32 v83, v99
    ds_read_b32 v131, v99 offset:4160
    ds_read_b32 v84, v100
    ds_read_b32 v132, v100 offset:4160
    ds_read_b32 v85, v101
    ds_read_b32 v133, v101 offset:4160
    ds_read_b32 v86, v102
    ds_read_b32 v134, v102 offset:4160
    ds_read_b32 v87, v103
    ds_read_b32 v135, v103 offset:4160
    ds_read_b32 v70, v39
    ds_read_b32 v136, v39 offset:4160
    s_waitcnt lgkmcnt(15)
    v_add_f32 v72, v72, v120
    v_add_f32 v73, v73, v121
    v_add_f32 v74, v74, v122
    v_add_f32 v75, v75, v123
    v_add_f32 v76, v76, v124
    v_add_f32 v77, v77, v125
    v_add_f32 v78, v78, v126
    v_add_f32 v79, v79, v127
    v_add_f32 v80, v80, v128
    s_waitcnt lgkmcnt(14)
    v_add_f32 v81, v81, v129
    s_waitcnt lgkmcnt(12)
    v_add_f32 v82, v82, v130
    s_waitcnt lgkmcnt(10)
    v_add_f32 v83, v83, v131
    s_waitcnt lgkmcnt(8)
    v_add_f32 v84, v84, v132
    s_waitcnt lgkmcnt(6)
    v_add_f32 v85, v85, v133
    s_waitcnt lgkmcnt(4)
    v_add_f32 v86, v86, v134
    s_waitcnt lgkmcnt(2)
    v_add_f32 v87, v87, v135
    s_waitcnt lgkmcnt(0)
    v_add_f32 v70, v70, v136
    v_add_f32 v87, v87, v27
    v_cndmask_b32 v70, v70, 0, s[34:35]
    v_cvt_pk_bf16_f32 v104, v72, v73
    v_cvt_pk_bf16_f32 v105, v74, v75
    v_cvt_pk_bf16_f32 v106, v76, v77
    v_cvt_pk_bf16_f32 v107, v78, v79
    v_cvt_pk_bf16_f32 v108, v80, v81
    v_cvt_pk_bf16_f32 v109, v82, v83
    v_cvt_pk_bf16_f32 v110, v84, v85
    v_cvt_pk_bf16_f32 v111, v86, v87
    ds_write_b128 v26, v[104:107] offset:0
    ds_write_b128 v26, v[108:111] offset:16
    v_cvt_pk_bf16_f32 v112, v73, v74
    v_cvt_pk_bf16_f32 v113, v75, v76
    v_cvt_pk_bf16_f32 v114, v77, v78
    v_cvt_pk_bf16_f32 v115, v79, v80
    v_cvt_pk_bf16_f32 v116, v81, v82
    v_cvt_pk_bf16_f32 v117, v83, v84
    v_cvt_pk_bf16_f32 v118, v85, v86
    v_cvt_pk_bf16_f32 v119, v87, v70
    ds_write_b128 v26, v[112:115] offset:4160
    ds_write_b128 v26, v[116:119] offset:4176
    ds_write_b32 v14, v16 offset:16
    s_waitcnt vmcnt(0)
    v_cmp_ne_u32 vcc, s60, v37
    s_nop 0
    s_cbranch_vccnz Lgs64
Lgk65:
    buffer_load_dwordx4 v[48:51], v10, s[48:51], s72 offen offset:0 sc1
    buffer_load_dwordx4 v[52:55], v10, s[48:51], s72 offen offset:1024 sc1
    buffer_load_dwordx4 v[56:59], v10, s[48:51], s72 offen offset:2048 sc1
    buffer_load_dwordx4 v[60:63], v10, s[48:51], s72 offen offset:3072 sc1
    buffer_load_dwordx4 v[40:43], v38, s[48:51], 0 offen offset:0 sc1
    buffer_load_dwordx4 v[44:47], v38, s[48:51], 0 offen offset:64 sc1
    s_waitcnt vmcnt(1)
    v_lshlrev_b32 v64, 16, v40
    v_and_b32 v65, 0xffff0000, v40
    v_lshlrev_b32 v66, 16, v41
    v_and_b32 v67, 0xffff0000, v41
    v_fma_f32 v64, v64, v48, v49
    v_fma_f32 v65, v65, v50, v51
    v_fma_f32 v66, v66, v52, v53
    v_fma_f32 v67, v67, v54, v55
    v_cvt_pk_bf16_f32 v40, v64, v65
    v_cvt_pk_bf16_f32 v41, v66, v67
    v_lshlrev_b32 v64, 16, v42
    v_and_b32 v65, 0xffff0000, v42
    v_lshlrev_b32 v66, 16, v43
    v_and_b32 v67, 0xffff0000, v43
    v_fma_f32 v64, v64, v56, v57
    v_fma_f32 v65, v65, v58, v59
    v_fma_f32 v66, v66, v60, v61
    v_fma_f32 v67, v67, v62, v63
    v_cvt_pk_bf16_f32 v42, v64, v65
    v_cvt_pk_bf16_f32 v43, v66, v67
    ds_write_b128 v11, v[40:43] offset:0
    s_waitcnt vmcnt(0)
    v_lshlrev_b32 v64, 16, v44
    v_and_b32 v65, 0xffff0000, v44
    v_lshlrev_b32 v66, 16, v45
    v_and_b32 v67, 0xffff0000, v45
    v_fma_f32 v64, v64, v48, v49
    v_fma_f32 v65, v65, v50, v51
    v_fma_f32 v66, v66, v52, v53
    v_fma_f32 v67, v67, v54, v55
    v_cvt_pk_bf16_f32 v44, v64, v65
    v_cvt_pk_bf16_f32 v45, v66, v67
    v_lshlrev_b32 v64, 16, v46
    v_and_b32 v65, 0xffff0000, v46
    v_lshlrev_b32 v66, 16, v47
    v_and_b32 v67, 0xffff0000, v47
    v_fma_f32 v64, v64, v56, v57
    v_fma_f32 v65, v65, v58, v59
    v_fma_f32 v66, v66, v60, v61
    v_fma_f32 v67, v67, v62, v63
    v_cvt_pk_bf16_f32 v46, v64, v65
    v_cvt_pk_bf16_f32 v47, v66, v67
    ds_write_b128 v11, v[44:47] offset:4608
    ds_write_b32 v14, v16 offset:48
    ds_read_b32 v17, v12 offset:16
    s_waitcnt lgkmcnt(0)
    v_cmp_gt_u32 vcc, 1, v17
    s_nop 0
    s_cbranch_vccnz Lvp70
Lvk71:
    ds_read2_b32 v[72:73], v28 offset0:224 offset1:225
    ds_read2_b32 v[74:75], v28 offset0:226 offset1:227
    ds_read_b128 v[104:107], v32 offset:384
    ds_read_b128 v[108:111], v32 offset:896
    ds_read_b128 v[112:115], v32 offset:1408
    ds_read_b128 v[116:119], v32 offset:1920
    ds_read_b128 v[120:123], v32 offset:2432
    ds_read_b128 v[124:127], v32 offset:2944
    ds_read_b128 v[128:131], v32 offset:3456
    ds_read_b128 v[132:135], v32 offset:3968
    ds_read2_b32 v[76:77], v28 offset0:96 offset1:97
    ds_read2_b32 v[78:79], v28 offset0:98 offset1:99
    ds_read2_b32 v[80:81], v29 offset0:224 offset1:225
    ds_read2_b32 v[82:83], v29 offset0:226 offset1:227
    ds_read2_b32 v[84:85], v29 offset0:96 offset1:97
    ds_read2_b32 v[86:87], v29 offset0:98 offset1:99
    ds_read2_b32 v[88:89], v30 offset0:224 offset1:225
    ds_read2_b32 v[90:91], v30 offset0:226 offset1:227
    ds_read2_b32 v[92:93], v30 offset0:96 offset1:97
    ds_read2_b32 v[94:95], v30 offset0:98 offset1:99
    ds_read2_b32 v[96:97], v31 offset0:224 offset1:225
    ds_read2_b32 v[98:99], v31 offset0:226 offset1:227
    ds_read2_b32 v[100:101], v31 offset0:96 offset1:97
    ds_read2_b32 v[102:103], v31 offset0:98 offset1:99
    s_lshr_b32 s61, s78, 5
    s_lshl_b32 s61, s61, 1
    s_add_u32 s61, s61, s77
    s_lshl_b32 s61, s61, 7
    s_and_b32 s62, s78, 31
    s_lshl_b32 s62, s62, 2
    s_add_u32 s61, s61, s62
    s_add_u32 s61, s61, 0x48000
    v_mov_b32 v140, s61
    v_mov_b32 v141, s60
    ds_read_b32 v17, v14 offset:80
    s_waitcnt lgkmcnt(0)
    v_readfirstlane_b32 s61, v17
    s_nop 0
    s_cmp_lt_u32 s61, 9
    s_cbranch_scc1 Lsp73
Lok74:
    s_setprio 3
    v_mfma_f32_16x16x32_bf16 v[40:43], v[72:75], v[104:107], 0
    ds_read2_b32 a[0:1], v28 offset0:192 offset1:193
    v_mfma_f32_16x16x32_bf16 v[44:47], v[72:75], v[108:111], 0
    ds_read2_b32 a[2:3], v28 offset0:194 offset1:195
    v_mfma_f32_16x16x32_bf16 v[48:51], v[72:75], v[112:115], 0
    ds_read_b128 a[32:35], v32 offset:256
    v_mfma_f32_16x16x32_bf16 v[52:55], v[72:75], v[116:119], 0
    ds_read_b128 a[36:39], v32 offset:768
    v_mfma_f32_16x16x32_bf16 v[56:59], v[72:75], v[120:123], 0
    ds_read_b128 a[40:43], v32 offset:1280
    v_mfma_f32_16x16x32_bf16 v[60:63], v[72:75], v[124:127], 0
    ds_read_b128 a[44:47], v32 offset:1792
    v_mfma_f32_16x16x32_bf16 v[64:67], v[72:75], v[128:131], 0
    ds_read_b128 a[48:51], v32 offset:2304
    v_mfma_f32_16x16x32_bf16 v[68:71], v[72:75], v[132:135], 0
    ds_read_b128 a[52:55], v32 offset:2816
    v_mfma_f32_16x16x32_bf16 v[44:47], v[76:79], v[104:107], v[44:47]
    ds_read_b128 a[56:59], v32 offset:3328
    v_mfma_f32_16x16x32_bf16 v[48:51], v[76:79], v[108:111], v[48:51]
    ds_read_b128 a[60:63], v32 offset:3840
    v_mfma_f32_16x16x32_bf16 v[52:55], v[76:79], v[112:115], v[52:55]
    ds_read2_b32 a[4:5], v28 offset0:64 offset1:65
    v_mfma_f32_16x16x32_bf16 v[56:59], v[76:79], v[116:119], v[56:59]
    ds_read2_b32 a[6:7], v28 offset0:66 offset1:67
    v_mfma_f32_16x16x32_bf16 v[60:63], v[76:79], v[120:123], v[60:63]
    ds_read2_b32 a[8:9], v29 offset0:192 offset1:193
    v_mfma_f32_16x16x32_bf16 v[64:67], v[76:79], v[124:127], v[64:67]
    ds_read2_b32 a[10:11], v29 offset0:194 offset1:195
    v_mfma_f32_16x16x32_bf16 v[68:71], v[76:79], v[128:131], v[68:71]
    ds_read2_b32 a[12:13], v29 offset0:64 offset1:65
    v_mfma_f32_16x16x32_bf16 v[48:51], v[80:83], v[104:107], v[48:51]
    ds_read2_b32 a[14:15], v29 offset0:66 offset1:67
    v_mfma_f32_16x16x32_bf16 v[52:55], v[80:83], v[108:111], v[52:55]
    ds_read2_b32 a[16:17], v30 offset0:192 offset1:193
    v_mfma_f32_16x16x32_bf16 v[56:59], v[80:83], v[112:115], v[56:59]
    ds_read2_b32 a[18:19], v30 offset0:194 offset1:195
    v_mfma_f32_16x16x32_bf16 v[60:63], v[80:83], v[116:119], v[60:63]
    ds_read2_b32 a[20:21], v30 offset0:64 offset1:65
    v_mfma_f32_16x16x32_bf16 v[64:67], v[80:83], v[120:123], v[64:67]
    ds_read2_b32 a[22:23], v30 offset0:66 offset1:67
    v_mfma_f32_16x16x32_bf16 v[68:71], v[80:83], v[124:127], v[68:71]
    ds_read2_b32 a[24:25], v31 offset0:192 offset1:193
    v_mfma_f32_16x16x32_bf16 v[52:55], v[84:87], v[104:107], v[52:55]
    ds_read2_b32 a[26:27], v31 offset0:194 offset1:195
    v_mfma_f32_16x16x32_bf16 v[56:59], v[84:87], v[108:111], v[56:59]
    ds_read2_b32 a[28:29], v31 offset0:64 offset1:65
    v_mfma_f32_16x16x32_bf16 v[60:63], v[84:87], v[112:115], v[60:63]
    ds_read2_b32 a[30:31], v31 offset0:66 offset1:67
    v_mfma_f32_16x16x32_bf16 v[64:67], v[84:87], v[116:119], v[64:67]
    v_mfma_f32_16x16x32_bf16 v[68:71], v[84:87], v[120:123], v[68:71]
    v_mfma_f32_16x16x32_bf16 v[56:59], v[88:91], v[104:107], v[56:59]
    v_mfma_f32_16x16x32_bf16 v[60:63], v[88:91], v[108:111], v[60:63]
    v_mfma_f32_16x16x32_bf16 v[64:67], v[88:91], v[112:115], v[64:67]
    v_mfma_f32_16x16x32_bf16 v[68:71], v[88:91], v[116:119], v[68:71]
    v_mfma_f32_16x16x32_bf16 v[60:63], v[92:95], v[104:107], v[60:63]
    v_mfma_f32_16x16x32_bf16 v[64:67], v[92:95], v[108:111], v[64:67]
    v_mfma_f32_16x16x32_bf16 v[68:71], v[92:95], v[112:115], v[68:71]
    v_mfma_f32_16x16x32_bf16 v[64:67], v[96:99], v[104:107], v[64:67]
    v_mfma_f32_16x16x32_bf16 v[68:71], v[96:99], v[108:111], v[68:71]
    v_mfma_f32_16x16x32_bf16 v[68:71], v[100:103], v[104:107], v[68:71]
    s_waitcnt lgkmcnt(15)
    v_mfma_f32_16x16x32_bf16 v[40:43], a[0:3], a[32:35], v[40:43]
    ds_read2_b32 v[72:73], v28 offset0:160 offset1:161
    v_mfma_f32_16x16x32_bf16 v[44:47], a[0:3], a[36:39], v[44:47]
    ds_read2_b32 v[74:75], v28 offset0:162 offset1:163
    v_mfma_f32_16x16x32_bf16 v[48:51], a[0:3], a[40:43], v[48:51]
    ds_read_b128 v[104:107], v32 offset:128
    v_mfma_f32_16x16x32_bf16 v[52:55], a[0:3], a[44:47], v[52:55]
    ds_read_b128 v[108:111], v32 offset:640
    v_mfma_f32_16x16x32_bf16 v[56:59], a[0:3], a[48:51], v[56:59]
    ds_read_b128 v[112:115], v32 offset:1152
    v_mfma_f32_16x16x32_bf16 v[60:63], a[0:3], a[52:55], v[60:63]
    ds_read_b128 v[116:119], v32 offset:1664
    v_mfma_f32_16x16x32_bf16 v[64:67], a[0:3], a[56:59], v[64:67]
    ds_read_b128 v[120:123], v32 offset:2176
    s_waitcnt lgkmcnt(15)
    v_mfma_f32_16x16x32_bf16 v[68:71], a[0:3], a[60:63], v[68:71]
    ds_read_b128 v[124:127], v32 offset:2688
    v_mfma_f32_16x16x32_bf16 v[44:47], a[4:7], a[32:35], v[44:47]
    ds_read_b128 v[128:131], v32 offset:3200
    v_mfma_f32_16x16x32_bf16 v[48:51], a[4:7], a[36:39], v[48:51]
    ds_read_b128 v[132:135], v32 offset:3712
    v_mfma_f32_16x16x32_bf16 v[52:55], a[4:7], a[40:43], v[52:55]
    ds_read2_b32 v[76:77], v28 offset0:32 offset1:33
    v_mfma_f32_16x16x32_bf16 v[56:59], a[4:7], a[44:47], v[56:59]
    ds_read2_b32 v[78:79], v28 offset0:34 offset1:35
    v_mfma_f32_16x16x32_bf16 v[60:63], a[4:7], a[48:51], v[60:63]
    ds_read2_b32 v[80:81], v29 offset0:160 offset1:161
    v_mfma_f32_16x16x32_bf16 v[64:67], a[4:7], a[52:55], v[64:67]
    ds_read2_b32 v[82:83], v29 offset0:162 offset1:163
    v_mfma_f32_16x16x32_bf16 v[68:71], a[4:7], a[56:59], v[68:71]
    ds_read2_b32 v[84:85], v29 offset0:32 offset1:33
    v_mfma_f32_16x16x32_bf16 v[48:51], a[8:11], a[32:35], v[48:51]
    ds_read2_b32 v[86:87], v29 offset0:34 offset1:35
    v_mfma_f32_16x16x32_bf16 v[52:55], a[8:11], a[36:39], v[52:55]
    ds_read2_b32 v[88:89], v30 offset0:160 offset1:161
    v_mfma_f32_16x16x32_bf16 v[56:59], a[8:11], a[40:43], v[56:59]
    ds_read2_b32 v[90:91], v30 offset0:162 offset1:163
    v_mfma_f32_16x16x32_bf16 v[60:63], a[8:11], a[44:47], v[60:63]
    ds_read2_b32 v[92:93], v30 offset0:32 offset1:33
    v_mfma_f32_16x16x32_bf16 v[64:67], a[8:11], a[48:51], v[64:67]
    ds_read2_b32 v[94:95], v30 offset0:34 offset1:35
    v_mfma_f32_16x16x32_bf16 v[68:71], a[8:11], a[52:55], v[68:71]
    ds_read2_b32 v[96:97], v31 offset0:160 offset1:161
    v_mfma_f32_16x16x32_bf16 v[52:55], a[12:15], a[32:35], v[52:55]
    ds_read2_b32 v[98:99], v31 offset0:162 offset1:163
    v_mfma_f32_16x16x32_bf16 v[56:59], a[12:15], a[36:39], v[56:59]
    ds_read2_b32 v[100:101], v31 offset0:32 offset1:33
    v_mfma_f32_16x16x32_bf16 v[60:63], a[12:15], a[40:43], v[60:63]
    ds_read2_b32 v[102:103], v31 offset0:34 offset1:35
    v_mfma_f32_16x16x32_bf16 v[64:67], a[12:15], a[44:47], v[64:67]
    v_mfma_f32_16x16x32_bf16 v[68:71], a[12:15], a[48:51], v[68:71]
    s_waitcnt lgkmcnt(15)
    v_mfma_f32_16x16x32_bf16 v[56:59], a[16:19], a[32:35], v[56:59]
    v_mfma_f32_16x16x32_bf16 v[60:63], a[16:19], a[36:39], v[60:63]
    v_mfma_f32_16x16x32_bf16 v[64:67], a[16:19], a[40:43], v[64:67]
    v_mfma_f32_16x16x32_bf16 v[68:71], a[16:19], a[44:47], v[68:71]
    v_mfma_f32_16x16x32_bf16 v[60:63], a[20:23], a[32:35], v[60:63]
    v_mfma_f32_16x16x32_bf16 v[64:67], a[20:23], a[36:39], v[64:67]
    v_mfma_f32_16x16x32_bf16 v[68:71], a[20:23], a[40:43], v[68:71]
    v_mfma_f32_16x16x32_bf16 v[64:67], a[24:27], a[32:35], v[64:67]
    v_mfma_f32_16x16x32_bf16 v[68:71], a[24:27], a[36:39], v[68:71]
    v_mfma_f32_16x16x32_bf16 v[68:71], a[28:31], a[32:35], v[68:71]
    v_mfma_f32_16x16x32_bf16 v[40:43], v[72:75], v[104:107], v[40:43]
    ds_read2_b32 a[0:1], v28 offset0:128 offset1:129
    v_mfma_f32_16x16x32_bf16 v[44:47], v[72:75], v[108:111], v[44:47]
    ds_read2_b32 a[2:3], v28 offset0:130 offset1:131
    v_mfma_f32_16x16x32_bf16 v[48:51], v[72:75], v[112:115], v[48:51]
    ds_read_b128 a[32:35], v32 offset:0
    v_mfma_f32_16x16x32_bf16 v[52:55], v[72:75], v[116:119], v[52:55]
    ds_read_b128 a[36:39], v32 offset:512
    v_mfma_f32_16x16x32_bf16 v[56:59], v[72:75], v[120:123], v[56:59]
    ds_read_b128 a[40:43], v32 offset:1024
    v_mfma_f32_16x16x32_bf16 v[60:63], v[72:75], v[124:127], v[60:63]
    ds_read_b128 a[44:47], v32 offset:1536
    v_mfma_f32_16x16x32_bf16 v[64:67], v[72:75], v[128:131], v[64:67]
    ds_read_b128 a[48:51], v32 offset:2048
    s_waitcnt lgkmcnt(15)
    v_mfma_f32_16x16x32_bf16 v[68:71], v[72:75], v[132:135], v[68:71]
    ds_read_b128 a[52:55], v32 offset:2560
    v_mfma_f32_16x16x32_bf16 v[44:47], v[76:79], v[104:107], v[44:47]
    ds_read_b128 a[56:59], v32 offset:3072
    v_mfma_f32_16x16x32_bf16 v[48:51], v[76:79], v[108:111], v[48:51]
    ds_read_b128 a[60:63], v32 offset:3584
    v_mfma_f32_16x16x32_bf16 v[52:55], v[76:79], v[112:115], v[52:55]
    ds_read2_b32 a[4:5], v28 offset0:0 offset1:1
    v_mfma_f32_16x16x32_bf16 v[56:59], v[76:79], v[116:119], v[56:59]
    ds_read2_b32 a[6:7], v28 offset0:2 offset1:3
    v_mfma_f32_16x16x32_bf16 v[60:63], v[76:79], v[120:123], v[60:63]
    ds_read2_b32 a[8:9], v29 offset0:128 offset1:129
    v_mfma_f32_16x16x32_bf16 v[64:67], v[76:79], v[124:127], v[64:67]
    ds_read2_b32 a[10:11], v29 offset0:130 offset1:131
    v_mfma_f32_16x16x32_bf16 v[68:71], v[76:79], v[128:131], v[68:71]
    ds_read2_b32 a[12:13], v29 offset0:0 offset1:1
    v_mfma_f32_16x16x32_bf16 v[48:51], v[80:83], v[104:107], v[48:51]
    ds_read2_b32 a[14:15], v29 offset0:2 offset1:3
    v_mfma_f32_16x16x32_bf16 v[52:55], v[80:83], v[108:111], v[52:55]
    ds_read2_b32 a[16:17], v30 offset0:128 offset1:129
    v_mfma_f32_16x16x32_bf16 v[56:59], v[80:83], v[112:115], v[56:59]
    ds_read2_b32 a[18:19], v30 offset0:130 offset1:131
    v_mfma_f32_16x16x32_bf16 v[60:63], v[80:83], v[116:119], v[60:63]
    ds_read2_b32 a[20:21], v30 offset0:0 offset1:1
    v_mfma_f32_16x16x32_bf16 v[64:67], v[80:83], v[120:123], v[64:67]
    ds_read2_b32 a[22:23], v30 offset0:2 offset1:3
    v_mfma_f32_16x16x32_bf16 v[68:71], v[80:83], v[124:127], v[68:71]
    ds_read2_b32 a[24:25], v31 offset0:128 offset1:129
    v_mfma_f32_16x16x32_bf16 v[52:55], v[84:87], v[104:107], v[52:55]
    ds_read2_b32 a[26:27], v31 offset0:130 offset1:131
    v_mfma_f32_16x16x32_bf16 v[56:59], v[84:87], v[108:111], v[56:59]
    ds_read2_b32 a[28:29], v31 offset0:0 offset1:1
    v_mfma_f32_16x16x32_bf16 v[60:63], v[84:87], v[112:115], v[60:63]
    ds_read2_b32 a[30:31], v31 offset0:2 offset1:3
    v_mfma_f32_16x16x32_bf16 v[64:67], v[84:87], v[116:119], v[64:67]
    v_mfma_f32_16x16x32_bf16 v[68:71], v[84:87], v[120:123], v[68:71]
    s_waitcnt lgkmcnt(15)
    v_mfma_f32_16x16x32_bf16 v[56:59], v[88:91], v[104:107], v[56:59]
    v_mfma_f32_16x16x32_bf16 v[60:63], v[88:91], v[108:111], v[60:63]
    v_mfma_f32_16x16x32_bf16 v[64:67], v[88:91], v[112:115], v[64:67]
    v_mfma_f32_16x16x32_bf16 v[68:71], v[88:91], v[116:119], v[68:71]
    v_mfma_f32_16x16x32_bf16 v[60:63], v[92:95], v[104:107], v[60:63]
    v_mfma_f32_16x16x32_bf16 v[64:67], v[92:95], v[108:111], v[64:67]
    v_mfma_f32_16x16x32_bf16 v[68:71], v[92:95], v[112:115], v[68:71]
    v_mfma_f32_16x16x32_bf16 v[64:67], v[96:99], v[104:107], v[64:67]
    v_mfma_f32_16x16x32_bf16 v[68:71], v[96:99], v[108:111], v[68:71]
    v_mfma_f32_16x16x32_bf16 v[68:71], v[100:103], v[104:107], v[68:71]
    ds_read_b32 v17, v13 offset:80
    s_cmp_lg_u32 s77, 0
    s_cbranch_scc1 Lc177
    s_waitcnt lgkmcnt(15)
    v_mfma_f32_16x16x32_bf16 v[68:71], a[0:3], a[60:63], v[68:71]
    v_mfma_f32_16x16x32_bf16 v[64:67], a[0:3], a[56:59], v[64:67]
    s_waitcnt lgkmcnt(13)
    v_mfma_f32_16x16x32_bf16 v[68:71], a[4:7], a[56:59], v[68:71]
    v_mfma_f32_16x16x32_bf16 v[64:67], a[4:7], a[52:55], v[64:67]
    s_waitcnt lgkmcnt(11)
    v_mfma_f32_16x16x32_bf16 v[68:71], a[8:11], a[52:55], v[68:71]
    v_mfma_f32_16x16x32_bf16 v[64:67], a[8:11], a[48:51], v[64:67]
    s_waitcnt lgkmcnt(9)
    v_mfma_f32_16x16x32_bf16 v[68:71], a[12:15], a[48:51], v[68:71]
    v_mfma_f32_16x16x32_bf16 v[64:67], a[12:15], a[44:47], v[64:67]
    s_waitcnt lgkmcnt(7)
    v_mfma_f32_16x16x32_bf16 v[68:71], a[16:19], a[44:47], v[68:71]
    v_mfma_f32_16x16x32_bf16 v[64:67], a[16:19], a[40:43], v[64:67]
    s_waitcnt lgkmcnt(5)
    v_mfma_f32_16x16x32_bf16 v[68:71], a[20:23], a[40:43], v[68:71]
    v_mfma_f32_16x16x32_bf16 v[64:67], a[20:23], a[36:39], v[64:67]
    s_waitcnt lgkmcnt(3)
    v_mfma_f32_16x16x32_bf16 v[68:71], a[24:27], a[36:39], v[68:71]
    v_mfma_f32_16x16x32_bf16 v[64:67], a[24:27], a[32:35], v[64:67]
    s_waitcnt lgkmcnt(1)
    v_mfma_f32_16x16x32_bf16 v[68:71], a[28:31], a[32:35], v[68:71]
    v_mfma_f32_16x16x32_bf16 v[60:63], a[0:3], a[52:55], v[60:63]
    v_mfma_f32_16x16x32_bf16 v[56:59], a[0:3], a[48:51], v[56:59]
    v_mfma_f32_16x16x32_bf16 v[60:63], a[4:7], a[48:51], v[60:63]
    v_mfma_f32_16x16x32_bf16 v[56:59], a[4:7], a[44:47], v[56:59]
    v_mfma_f32_16x16x32_bf16 v[60:63], a[8:11], a[44:47], v[60:63]
    v_mfma_f32_16x16x32_bf16 v[56:59], a[8:11], a[40:43], v[56:59]
    v_mfma_f32_16x16x32_bf16 v[60:63], a[12:15], a[40:43], v[60:63]
    v_mfma_f32_16x16x32_bf16 v[56:59], a[12:15], a[36:39], v[56:59]
    v_mfma_f32_16x16x32_bf16 v[60:63], a[16:19], a[36:39], v[60:63]
    v_mfma_f32_16x16x32_bf16 v[56:59], a[16:19], a[32:35], v[56:59]
    v_mfma_f32_16x16x32_bf16 v[60:63], a[20:23], a[32:35], v[60:63]
    s_waitcnt lgkmcnt(0)
    v_cmp_gt_u32 vcc, 8, v17
    s_nop 0
    s_cbranch_vccnz Lvp78
Lvk79:
    v_mfma_f32_16x16x32_bf16 v[40:43], a[0:3], a[32:35], v[40:43]
    v_mfma_f32_16x16x32_bf16 v[44:47], a[0:3], a[36:39], v[44:47]
    ds_write_b128 v33, v[68:71] offset:3072
    v_mfma_f32_16x16x32_bf16 v[48:51], a[0:3], a[40:43], v[48:51]
    ds_write_b128 v33, v[64:67] offset:2048
    v_mfma_f32_16x16x32_bf16 v[52:55], a[0:3], a[44:47], v[52:55]
    ds_write_b128 v33, v[60:63] offset:1024
    v_mfma_f32_16x16x32_bf16 v[44:47], a[4:7], a[32:35], v[44:47]
    ds_write_b128 v33, v[56:59] offset:0
    v_mfma_f32_16x16x32_bf16 v[48:51], a[4:7], a[36:39], v[48:51]
    ds_write_b32 v14, v16 offset:32
    v_mfma_f32_16x16x32_bf16 v[52:55], a[4:7], a[40:43], v[52:55]
    v_mfma_f32_16x16x32_bf16 v[48:51], a[8:11], a[32:35], v[48:51]
    v_mfma_f32_16x16x32_bf16 v[52:55], a[8:11], a[36:39], v[52:55]
    v_mfma_f32_16x16x32_bf16 v[52:55], a[12:15], a[32:35], v[52:55]
    ds_read_b32 v37, v15 offset:32
    s_waitcnt lgkmcnt(0)
    v_readfirstlane_b32 s61, v37
    s_nop 0
    s_cmp_lt_u32 s61, 1
    s_cbranch_scc1 Lsp81
Lok82:
    ds_read_b128 v[72:75], v34 offset:0
    ds_read_b128 v[76:79], v34 offset:1024
    ds_read_b128 v[80:83], v34 offset:2048
    ds_read_b128 v[84:87], v34 offset:3072
    s_waitcnt lgkmcnt(3)
    v_pk_add_f32 v[40:41], v[40:41], v[72:73]
    v_pk_add_f32 v[42:43], v[42:43], v[74:75]
    v_cvt_pk_bf16_f32 v40, v40, v41
    v_cvt_pk_bf16_f32 v41, v42, v43
    buffer_store_dwordx2 v[40:41], v35, s[48:51], 0 offen offset:0 sc1
    s_waitcnt lgkmcnt(2)
    v_pk_add_f32 v[44:45], v[44:45], v[76:77]
    v_pk_add_f32 v[46:47], v[46:47], v[78:79]
    v_cvt_pk_bf16_f32 v44, v44, v45
    v_cvt_pk_bf16_f32 v45, v46, v47
    buffer_store_dwordx2 v[44:45], v35, s[48:51], 0 offen offset:512 sc1
    s_waitcnt lgkmcnt(1)
    v_pk_add_f32 v[48:49], v[48:49], v[80:81]
    v_pk_add_f32 v[50:51], v[50:51], v[82:83]
    v_cvt_pk_bf16_f32 v48, v48, v49
    v_cvt_pk_bf16_f32 v49, v50, v51
    buffer_store_dwordx2 v[48:49], v35, s[48:51], 0 offen offset:1024 sc1
    s_waitcnt lgkmcnt(0)
    v_pk_add_f32 v[52:53], v[52:53], v[84:85]
    v_pk_add_f32 v[54:55], v[54:55], v[86:87]
    v_cvt_pk_bf16_f32 v52, v52, v53
    v_cvt_pk_bf16_f32 v53, v54, v55
    buffer_store_dwordx2 v[52:53], v35, s[48:51], 0 offen offset:1536 sc1
    s_waitcnt lgkmcnt(0)
    s_branch Lcj76
Lc177:
    s_waitcnt lgkmcnt(9)
    v_mfma_f32_16x16x32_bf16 v[52:55], a[12:15], a[32:35], v[52:55]
    v_mfma_f32_16x16x32_bf16 v[52:55], a[8:11], a[36:39], v[52:55]
    v_mfma_f32_16x16x32_bf16 v[48:51], a[8:11], a[32:35], v[48:51]
    v_mfma_f32_16x16x32_bf16 v[52:55], a[4:7], a[40:43], v[52:55]
    v_mfma_f32_16x16x32_bf16 v[48:51], a[4:7], a[36:39], v[48:51]
    v_mfma_f32_16x16x32_bf16 v[44:47], a[4:7], a[32:35], v[44:47]
    v_mfma_f32_16x16x32_bf16 v[52:55], a[0:3], a[44:47], v[52:55]
    v_mfma_f32_16x16x32_bf16 v[48:51], a[0:3], a[40:43], v[48:51]
    v_mfma_f32_16x16x32_bf16 v[44:47], a[0:3], a[36:39], v[44:47]
    v_mfma_f32_16x16x32_bf16 v[40:43], a[0:3], a[32:35], v[40:43]
    s_waitcnt lgkmcnt(0)
    v_cmp_gt_u32 vcc, 8, v17
    s_nop 0
    s_cbranch_vccnz Lvp84
Lvk85:
    v_mfma_f32_16x16x32_bf16 v[56:59], a[0:3], a[48:51], v[56:59]
    v_mfma_f32_16x16x32_bf16 v[60:63], a[0:3], a[52:55], v[60:63]
    ds_write_b128 v33, v[52:55] offset:3072
    v_mfma_f32_16x16x32_bf16 v[56:59], a[4:7], a[44:47], v[56:59]
    ds_write_b128 v33, v[48:51] offset:2048
    v_mfma_f32_16x16x32_bf16 v[60:63], a[4:7], a[48:51], v[60:63]
    ds_write_b128 v33, v[44:47] offset:1024
    v_mfma_f32_16x16x32_bf16 v[56:59], a[8:11], a[40:43], v[56:59]
    ds_write_b128 v33, v[40:43] offset:0
    v_mfma_f32_16x16x32_bf16 v[60:63], a[8:11], a[44:47], v[60:63]
    ds_write_b32 v14, v16 offset:32
    v_mfma_f32_16x16x32_bf16 v[56:59], a[12:15], a[36:39], v[56:59]
    v_mfma_f32_16x16x32_bf16 v[60:63], a[12:15], a[40:43], v[60:63]
    v_mfma_f32_16x16x32_bf16 v[56:59], a[16:19], a[32:35], v[56:59]
    v_mfma_f32_16x16x32_bf16 v[60:63], a[16:19], a[36:39], v[60:63]
    v_mfma_f32_16x16x32_bf16 v[60:63], a[20:23], a[32:35], v[60:63]
    v_mfma_f32_16x16x32_bf16 v[64:67], a[0:3], a[56:59], v[64:67]
    v_mfma_f32_16x16x32_bf16 v[68:71], a[0:3], a[60:63], v[68:71]
    v_mfma_f32_16x16x32_bf16 v[64:67], a[4:7], a[52:55], v[64:67]
    v_mfma_f32_16x16x32_bf16 v[68:71], a[4:7], a[56:59], v[68:71]
    v_mfma_f32_16x16x32_bf16 v[64:67], a[8:11], a[48:51], v[64:67]
    v_mfma_f32_16x16x32_bf16 v[68:71], a[8:11], a[52:55], v[68:71]
    v_mfma_f32_16x16x32_bf16 v[64:67], a[12:15], a[44:47], v[64:67]
    v_mfma_f32_16x16x32_bf16 v[68:71], a[12:15], a[48:51], v[68:71]
    v_mfma_f32_16x16x32_bf16 v[64:67], a[16:19], a[40:43], v[64:67]
    v_mfma_f32_16x16x32_bf16 v[68:71], a[16:19], a[44:47], v[68:71]
    v_mfma_f32_16x16x32_bf16 v[64:67], a[20:23], a[36:39], v[64:67]
    v_mfma_f32_16x16x32_bf16 v[68:71], a[20:23], a[40:43], v[68:71]
    v_mfma_f32_16x16x32_bf16 v[64:67], a[24:27], a[32:35], v[64:67]
    v_mfma_f32_16x16x32_bf16 v[68:71], a[24:27], a[36:39], v[68:71]
    v_mfma_f32_16x16x32_bf16 v[68:71], a[28:31], a[32:35], v[68:71]
    ds_read_b32 v37, v15 offset:32
    s_waitcnt lgkmcnt(0)
    v_readfirstlane_b32 s61, v37
    s_nop 0
    s_cmp_lt_u32 s61, 1
    s_cbranch_scc1 Lsp87
Lok88:
    ds_read_b128 v[72:75], v34 offset:0
    ds_read_b128 v[76:79], v34 offset:1024
    ds_read_b128 v[80:83], v34 offset:2048
    ds_read_b128 v[84:87], v34 offset:3072
    s_waitcnt lgkmcnt(3)
    v_pk_add_f32 v[56:57], v[56:57], v[72:73]
    v_pk_add_f32 v[58:59], v[58:59], v[74:75]
    v_cvt_pk_bf16_f32 v56, v56, v57
    v_cvt_pk_bf16_f32 v57, v58, v59
    buffer_store_dwordx2 v[56:57], v35, s[48:51], 0 offen offset:0 sc1
    s_waitcnt lgkmcnt(2)
    v_pk_add_f32 v[60:61], v[60:61], v[76:77]
    v_pk_add_f32 v[62:63], v[62:63], v[78:79]
    v_cvt_pk_bf16_f32 v60, v60, v61
    v_cvt_pk_bf16_f32 v61, v62, v63
    buffer_store_dwordx2 v[60:61], v35, s[48:51], 0 offen offset:512 sc1
    s_waitcnt lgkmcnt(1)
    v_pk_add_f32 v[64:65], v[64:65], v[80:81]
    v_pk_add_f32 v[66:67], v[66:67], v[82:83]
    v_cvt_pk_bf16_f32 v64, v64, v65
    v_cvt_pk_bf16_f32 v65, v66, v67
    buffer_store_dwordx2 v[64:65], v35, s[48:51], 0 offen offset:1024 sc1
    s_waitcnt lgkmcnt(0)
    v_pk_add_f32 v[68:69], v[68:69], v[84:85]
    v_pk_add_f32 v[70:71], v[70:71], v[86:87]
    v_cvt_pk_bf16_f32 v68, v68, v69
    v_cvt_pk_bf16_f32 v69, v70, v71
    buffer_store_dwordx2 v[68:69], v35, s[48:51], 0 offen offset:1536 sc1
    s_waitcnt lgkmcnt(0)
Lcj76:
    v_mov_b32 v72, v140
    v_mov_b32 v73, v141
    s_mov_b64 exec, 1
    s_waitcnt vmcnt(0)
    buffer_store_dword v73, v72, s[48:51], 0 offen sc1
    s_mov_b64 exec, -1
    s_lshl_b32 s61, s2, 2
    s_add_u32 s61, s61, s57
    s_cmp_lg_u32 s61, 0
    s_cbranch_scc1 Lne90
    v_lshlrev_b32 v72, 4, v1
    v_add_u32 v72, 0x48000, v72
    buffer_load_dwordx4 v[76:79], v72, s[48:51], 0 offen offset:0 sc1
    buffer_load_dwordx4 v[80:83], v72, s[48:51], 0 offen offset:1024 sc1
    buffer_load_dwordx4 v[84:87], v72, s[48:51], 0 offen offset:2048 sc1
    buffer_load_dwordx4 v[88:91], v72, s[48:51], 0 offen offset:3072 sc1
    s_waitcnt vmcnt(3)
    v_cmp_ne_u32 vcc, s60, v76
    v_cmp_ne_u32 s[74:75], s60, v77
    s_nop 0
    s_or_b64 vcc, vcc, s[74:75]
    v_cmp_ne_u32 s[74:75], s60, v78
    s_nop 0
    s_or_b64 vcc, vcc, s[74:75]
    v_cmp_ne_u32 s[74:75], s60, v79
    s_nop 0
    s_or_b64 vcc, vcc, s[74:75]
    s_waitcnt vmcnt(2)
    v_cmp_ne_u32 s[74:75], s60, v80
    s_nop 0
    s_or_b64 vcc, vcc, s[74:75]
    v_cmp_ne_u32 s[74:75], s60, v81
    s_nop 0
    s_or_b64 vcc, vcc, s[74:75]
    v_cmp_ne_u32 s[74:75], s60, v82
    s_nop 0
    s_or_b64 vcc, vcc, s[74:75]
    v_cmp_ne_u32 s[74:75], s60, v83
    s_nop 0
    s_or_b64 vcc, vcc, s[74:75]
    s_waitcnt vmcnt(1)
    v_cmp_ne_u32 s[74:75], s60, v84
    s_nop 0
    s_or_b64 vcc, vcc, s[74:75]
    v_cmp_ne_u32 s[74:75], s60, v85
    s_nop 0
    s_or_b64 vcc, vcc, s[74:75]
    v_cmp_ne_u32 s[74:75], s60, v86
    s_nop 0
    s_or_b64 vcc, vcc, s[74:75]
    v_cmp_ne_u32 s[74:75], s60, v87
    s_nop 0
    s_or_b64 vcc, vcc, s[74:75]
    s_waitcnt vmcnt(0)
    v_cmp_ne_u32 s[74:75], s60, v88
    s_nop 0
    s_or_b64 vcc, vcc, s[74:75]
    v_cmp_ne_u32 s[74:75], s60, v89
    s_nop 0
    s_or_b64 vcc, vcc, s[74:75]
    v_cmp_ne_u32 s[74:75], s60, v90
    s_nop 0
    s_or_b64 vcc, vcc, s[74:75]
    v_cmp_ne_u32 s[74:75], s60, v91
    s_nop 0
    s_or_b64 vcc, vcc, s[74:75]
    s_cbranch_vccnz Lgs91
Lgk92:
    v_mov_b32 v72, 0x10000
    s_mov_b64 exec, 1
    buffer_store_dword v73, v72, s[48:51], 0 offen sc1
    s_mov_b64 exec, -1
Lne90:
    s_waitcnt lgkmcnt(0)
    s_endpgm
Lvp1:
    s_mov_b32 s65, 0
Lvl3:
    ds_read_b32 v27, v157 offset:96
    s_add_u32 s65, s65, 1
    s_waitcnt lgkmcnt(0)
    v_cmp_gt_u32 vcc, 1, v27
    s_cmp_gt_u32 s65, 65536
    s_cbranch_scc1 Lvk2
    s_cbranch_vccnz Lvl3
    s_branch Lvk2
Lvp4:
    s_mov_b32 s65, 0
Lvl6:
    ds_read_b32 v27, v157 offset:64
    s_add_u32 s65, s65, 1
    s_waitcnt lgkmcnt(0)
    v_cmp_gt_u32 vcc, 1, v27
    s_cmp_gt_u32 s65, 65536
    s_cbranch_scc1 Lvk5
    s_cbranch_vccnz Lvl6
    s_branch Lvk5
Lvp7:
    s_mov_b32 s65, 0
Lvl9:
    ds_read_b32 v27, v157 offset:80
    s_add_u32 s65, s65, 1
    s_waitcnt lgkmcnt(0)
    v_cmp_gt_u32 vcc, 1, v27
    s_cmp_gt_u32 s65, 65536
    s_cbranch_scc1 Lvk8
    s_cbranch_vccnz Lvl9
    s_branch Lvk8
Lvp10:
    s_mov_b32 s65, 0
Lvl12:
    ds_read_b32 v27, v157 offset:64
    s_add_u32 s65, s65, 1
    s_waitcnt lgkmcnt(0)
    v_cmp_gt_u32 vcc, 2, v27
    s_cmp_gt_u32 s65, 65536
    s_cbranch_scc1 Lvk11
    s_cbranch_vccnz Lvl12
    s_branch Lvk11
Lvp13:
    s_mov_b32 s65, 0
Lvl15:
    ds_read_b32 v27, v157 offset:80
    s_add_u32 s65, s65, 1
    s_waitcnt lgkmcnt(0)
    v_cmp_gt_u32 vcc, 2, v27
    s_cmp_gt_u32 s65, 65536
    s_cbranch_scc1 Lvk14
    s_cbranch_vccnz Lvl15
    s_branch Lvk14
Lvp16:
    s_mov_b32 s65, 0
Lvl18:
    ds_read_b32 v27, v157 offset:64
    s_add_u32 s65, s65, 1
    s_waitcnt lgkmcnt(0)
    v_cmp_gt_u32 vcc, 3, v27
    s_cmp_gt_u32 s65, 65536
    s_cbranch_scc1 Lvk17
    s_cbranch_vccnz Lvl18
    s_branch Lvk17
Lvp19:
    s_mov_b32 s65, 0
Lvl21:
    ds_read_b32 v27, v157 offset:80
    s_add_u32 s65, s65, 1
    s_waitcnt lgkmcnt(0)
    v_cmp_gt_u32 vcc, 3, v27
    s_cmp_gt_u32 s65, 65536
    s_cbranch_scc1 Lvk20
    s_cbranch_vccnz Lvl21
    s_branch Lvk20
Lvp22:
    s_mov_b32 s65, 0
Lvl24:
    ds_read_b32 v27, v157 offset:64
    s_add_u32 s65, s65, 1
    s_waitcnt lgkmcnt(0)
    v_cmp_gt_u32 vcc, 4, v27
    s_cmp_gt_u32 s65, 65536
    s_cbranch_scc1 Lvk23
    s_cbranch_vccnz Lvl24
    s_branch Lvk23
Lvp25:
    s_mov_b32 s65, 0
Lvl27:
    ds_read_b32 v27, v157 offset:80
    s_add_u32 s65, s65, 1
    s_waitcnt lgkmcnt(0)
    v_cmp_gt_u32 vcc, 4, v27
    s_cmp_gt_u32 s65, 65536
    s_cbranch_scc1 Lvk26
    s_cbranch_vccnz Lvl27
    s_branch Lvk26
Lvp28:
    s_mov_b32 s65, 0
Lvl30:
    ds_read_b32 v27, v157 offset:64
    s_add_u32 s65, s65, 1
    s_waitcnt lgkmcnt(0)
    v_cmp_gt_u32 vcc, 5, v27
    s_cmp_gt_u32 s65, 65536
    s_cbranch_scc1 Lvk29
    s_cbranch_vccnz Lvl30
    s_branch Lvk29
Lvp31:
    s_mov_b32 s65, 0
Lvl33:
    ds_read_b32 v27, v157 offset:80
    s_add_u32 s65, s65, 1
    s_waitcnt lgkmcnt(0)
    v_cmp_gt_u32 vcc, 5, v27
    s_cmp_gt_u32 s65, 65536
    s_cbranch_scc1 Lvk32
    s_cbranch_vccnz Lvl33
    s_branch Lvk32
Lvp34:
    s_mov_b32 s65, 0
Lvl36:
    ds_read_b32 v27, v157 offset:64
    s_add_u32 s65, s65, 1
    s_waitcnt lgkmcnt(0)
    v_cmp_gt_u32 vcc, 6, v27
    s_cmp_gt_u32 s65, 65536
    s_cbranch_scc1 Lvk35
    s_cbranch_vccnz Lvl36
    s_branch Lvk35
Lvp37:
    s_mov_b32 s65, 0
Lvl39:
    ds_read_b32 v27, v157 offset:80
    s_add_u32 s65, s65, 1
    s_waitcnt lgkmcnt(0)
    v_cmp_gt_u32 vcc, 6, v27
    s_cmp_gt_u32 s65, 65536
    s_cbranch_scc1 Lvk38
    s_cbranch_vccnz Lvl39
    s_branch Lvk38
Lvp40:
    s_mov_b32 s65, 0
Lvl42:
    ds_read_b32 v27, v157 offset:64
    s_add_u32 s65, s65, 1
    s_waitcnt lgkmcnt(0)
    v_cmp_gt_u32 vcc, 7, v27
    s_cmp_gt_u32 s65, 65536
    s_cbranch_scc1 Lvk41
    s_cbranch_vccnz Lvl42
    s_branch Lvk41
Lvp43:
    s_mov_b32 s65, 0
Lvl45:
    ds_read_b32 v27, v157 offset:80
    s_add_u32 s65, s65, 1
    s_waitcnt lgkmcnt(0)
    v_cmp_gt_u32 vcc, 7, v27
    s_cmp_gt_u32 s65, 65536
    s_cbranch_scc1 Lvk44
    s_cbranch_vccnz Lvl45
    s_branch Lvk44
Lvp46:
    s_mov_b32 s65, 0
Lvl48:
    ds_read_b32 v27, v157 offset:80
    s_add_u32 s65, s65, 1
    s_waitcnt lgkmcnt(0)
    v_cmp_gt_u32 vcc, 8, v27
    s_cmp_gt_u32 s65, 65536
    s_cbranch_scc1 Lvk47
    s_cbranch_vccnz Lvl48
    s_branch Lvk47
Lgs49:
    s_mov_b32 s65, 0
Lgl51:
    buffer_load_dwordx4 v[2:5], v153, s[48:51], 0 offen offset:0 sc1
    buffer_load_dwordx4 v[6:9], v153, s[48:51], 0 offen offset:512 sc1
    s_add_u32 s65, s65, 1
    s_waitcnt vmcnt(0)
    v_cmp_ne_u32 vcc, s60, v4
    v_cmp_ne_u32 s[74:75], s60, v8
    s_nop 0
    s_or_b64 vcc, vcc, s[74:75]
    s_cmp_gt_u32 s65, 65536
    s_cbranch_scc1 Lgk50
    s_cbranch_vccnz Lgl51
    s_branch Lgk50
Lgs52:
    s_mov_b32 s65, 0
Lgl54:
    buffer_load_dword v3, v2, s[48:51], 0 offen sc1
    s_add_u32 s65, s65, 1
    s_waitcnt vmcnt(0)
    v_cmp_ne_u32 vcc, s60, v3
    s_cmp_gt_u32 s65, 65536
    s_cbranch_scc1 Lgk53
    s_cbranch_vccnz Lgl54
    s_branch Lgk53
Lgs55:
    s_mov_b32 s65, 0
Lgl57:
    buffer_load_dword v153, v3, s[48:51], 0 offen sc1
    s_add_u32 s65, s65, 1
    s_waitcnt vmcnt(0)
    v_cmp_ne_u32 vcc, s60, v153
    s_cmp_gt_u32 s65, 65536
    s_cbranch_scc1 Lgk56
    s_cbranch_vccnz Lgl57
    s_branch Lgk56
Lvp58:
    s_mov_b32 s65, 0
Lvl60:
    ds_read_b32 v27, v157 offset:112
    s_add_u32 s65, s65, 1
    s_waitcnt lgkmcnt(0)
    v_cmp_gt_u32 vcc, 1, v27
    s_cmp_gt_u32 s65, 65536
    s_cbranch_scc1 Lvk59
    s_cbranch_vccnz Lvl60
    s_branch Lvk59
Lvp61:
    s_mov_b32 s65, 0
Lvl63:
    ds_read_b32 v71, v13 offset:80
    s_add_u32 s65, s65, 1
    s_waitcnt lgkmcnt(0)
    v_cmp_gt_u32 vcc, 5, v71
    s_cmp_gt_u32 s65, 65536
    s_cbranch_scc1 Lvk62
    s_cbranch_vccnz Lvl63
    s_branch Lvk62
Lgs64:
    s_mov_b32 s65, 0
Lgl66:
    buffer_load_dword v37, v36, s[48:51], 0 offen sc1
    s_add_u32 s65, s65, 1
    s_waitcnt vmcnt(0)
    v_cmp_ne_u32 vcc, s60, v37
    s_cmp_gt_u32 s65, 65536
    s_cbranch_scc1 Lgk65
    s_cbranch_vccnz Lgl66
    s_branch Lgk65
Lsp67:
    s_mov_b32 s65, 0
Llp69:
    ds_read_b32 v17, v15 offset:0
    s_add_u32 s65, s65, 1
    s_waitcnt lgkmcnt(0)
    v_readfirstlane_b32 s61, v17
    s_cmp_gt_u32 s65, 65536
    s_cbranch_scc1 Lok68
    s_cmp_lt_u32 s61, 1
    s_cbranch_scc1 Llp69
    s_branch Lok68
Lvp70:
    s_mov_b32 s65, 0
Lvl72:
    ds_read_b32 v17, v12 offset:16
    s_add_u32 s65, s65, 1
    s_waitcnt lgkmcnt(0)
    v_cmp_gt_u32 vcc, 1, v17
    s_cmp_gt_u32 s65, 65536
    s_cbranch_scc1 Lvk71
    s_cbranch_vccnz Lvl72
    s_branch Lvk71
Lsp73:
    s_mov_b32 s65, 0
Llp75:
    ds_read_b32 v17, v14 offset:80
    s_add_u32 s65, s65, 1
    s_waitcnt lgkmcnt(0)
    v_readfirstlane_b32 s61, v17
    s_cmp_gt_u32 s65, 65536
    s_cbranch_scc1 Lok74
    s_cmp_lt_u32 s61, 9
    s_cbranch_scc1 Llp75
    s_branch Lok74
Lvp78:
    s_mov_b32 s65, 0
Lvl80:
    ds_read_b32 v17, v13 offset:80
    s_add_u32 s65, s65, 1
    s_waitcnt lgkmcnt(0)
    v_cmp_gt_u32 vcc, 8, v17
    s_cmp_gt_u32 s65, 65536
    s_cbranch_scc1 Lvk79
    s_cbranch_vccnz Lvl80
    s_branch Lvk79
Lsp81:
    s_mov_b32 s65, 0
Llp83:
    ds_read_b32 v37, v15 offset:32
    s_add_u32 s65, s65, 1
    s_waitcnt lgkmcnt(0)
    v_readfirstlane_b32 s61, v37
    s_cmp_gt_u32 s65, 65536
    s_cbranch_scc1 Lok82
    s_cmp_lt_u32 s61, 1
    s_cbranch_scc1 Llp83
    s_branch Lok82
Lvp84:
    s_mov_b32 s65, 0
Lvl86:
    ds_read_b32 v17, v13 offset:80
    s_add_u32 s65, s65, 1
    s_waitcnt lgkmcnt(0)
    v_cmp_gt_u32 vcc, 8, v17
    s_cmp_gt_u32 s65, 65536
    s_cbranch_scc1 Lvk85
    s_cbranch_vccnz Lvl86
    s_branch Lvk85
Lsp87:
    s_mov_b32 s65, 0
Llp89:
    ds_read_b32 v37, v15 offset:32
    s_add_u32 s65, s65, 1
    s_waitcnt lgkmcnt(0)
    v_readfirstlane_b32 s61, v37
    s_cmp_gt_u32 s65, 65536
    s_cbranch_scc1 Lok88
    s_cmp_lt_u32 s61, 1
    s_cbranch_scc1 Llp89
    s_branch Lok88
Lgs91:
    s_mov_b32 s65, 0
Lgl93:
    buffer_load_dwordx4 v[76:79], v72, s[48:51], 0 offen offset:0 sc1
    buffer_load_dwordx4 v[80:83], v72, s[48:51], 0 offen offset:1024 sc1
    buffer_load_dwordx4 v[84:87], v72, s[48:51], 0 offen offset:2048 sc1
    buffer_load_dwordx4 v[88:91], v72, s[48:51], 0 offen offset:3072 sc1
    s_add_u32 s65, s65, 1
    s_waitcnt vmcnt(0)
    v_cmp_ne_u32 vcc, s60, v76
    v_cmp_ne_u32 s[74:75], s60, v77
    s_nop 0
    s_or_b64 vcc, vcc, s[74:75]
    v_cmp_ne_u32 s[74:75], s60, v78
    s_nop 0
    s_or_b64 vcc, vcc, s[74:75]
    v_cmp_ne_u32 s[74:75], s60, v79
    s_nop 0
    s_or_b64 vcc, vcc, s[74:75]
    v_cmp_ne_u32 s[74:75], s60, v80
    s_nop 0
    s_or_b64 vcc, vcc, s[74:75]
    v_cmp_ne_u32 s[74:75], s60, v81
    s_nop 0
    s_or_b64 vcc, vcc, s[74:75]
    v_cmp_ne_u32 s[74:75], s60, v82
    s_nop 0
    s_or_b64 vcc, vcc, s[74:75]
    v_cmp_ne_u32 s[74:75], s60, v83
    s_nop 0
    s_or_b64 vcc, vcc, s[74:75]
    v_cmp_ne_u32 s[74:75], s60, v84
    s_nop 0
    s_or_b64 vcc, vcc, s[74:75]
    v_cmp_ne_u32 s[74:75], s60, v85
    s_nop 0
    s_or_b64 vcc, vcc, s[74:75]
    v_cmp_ne_u32 s[74:75], s60, v86
    s_nop 0
    s_or_b64 vcc, vcc, s[74:75]
    v_cmp_ne_u32 s[74:75], s60, v87
    s_nop 0
    s_or_b64 vcc, vcc, s[74:75]
    v_cmp_ne_u32 s[74:75], s60, v88
    s_nop 0
    s_or_b64 vcc, vcc, s[74:75]
    v_cmp_ne_u32 s[74:75], s60, v89
    s_nop 0
    s_or_b64 vcc, vcc, s[74:75]
    v_cmp_ne_u32 s[74:75], s60, v90
    s_nop 0
    s_or_b64 vcc, vcc, s[74:75]
    v_cmp_ne_u32 s[74:75], s60, v91
    s_nop 0
    s_or_b64 vcc, vcc, s[74:75]
    s_cmp_gt_u32 s65, 65536
    s_cbranch_scc1 Lgk92
    s_cbranch_vccnz Lgl93
    s_branch Lgk92
Lend:
    s_endpgm
.section .rodata,"a"
.p2align 6
.amdhsa_kernel parallel_sum__ssm_conv_s4d__mixer_channel_mlp__prompt_kernel
  .amdhsa_next_free_vgpr 256
  .amdhsa_next_free_sgpr 102
  .amdhsa_accum_offset 160
  .amdhsa_group_segment_fixed_size 0
  .amdhsa_kernarg_size 120
  .amdhsa_user_sgpr_count 2
  .amdhsa_user_sgpr_kernarg_segment_ptr 1
  .amdhsa_system_sgpr_workgroup_id_x 1
.end_amdhsa_kernel
```
